```python
import torch

def _softmax(x, axis=-1):
    return torch.softmax(x, dim=axis)
def _gelu(x):
    return torch.nn.functional.gelu(x, approximate="tanh")
def _silu(x):
    return torch.nn.functional.silu(x)
def _sigmoid(x):
    return torch.sigmoid(x)
def _layernorm(x, axis=-1, eps=1e-5):
    m = x.mean(dim=axis, keepdim=True)
    v = x.var(dim=axis, keepdim=True, unbiased=False)
    return (x - m) / torch.sqrt(v + eps)
def _scatter_add(tgt, idx, src, axis=0):
    return tgt.clone().index_add_(axis, idx, src)
def _segment_sum(src, seg, n):
    out = torch.zeros((n,) + src.shape[1:], dtype=src.dtype)
    return out.index_add_(0, seg, src)
def _pad(x, pw):
    flat = tuple(v for pair in reversed(pw) for v in pair)
    return torch.nn.functional.pad(x, flat)

kernel_name = 'parallel_sum__ssm_conv_h3__moe_arch_mod__prompt'

def setup_inputs():

    _w = (lambda a: (lambda t: t.to(torch.bfloat16) if t.is_floating_point() else t)(torch.as_tensor(a)))
    def _A_setup():
        B, S, D = 1, 2048, 640
        ks = 4
        return {
            "q": _w((lambda *s: torch.randn(*s, dtype=torch.bfloat16) * 0.05)(B, S, D)),
            "k": _w((lambda *s: torch.randn(*s, dtype=torch.bfloat16) * 0.4)(B, S, D)),
            "v": _w((lambda *s: torch.randn(*s, dtype=torch.bfloat16) * 0.4)(B, S, D)),
            "shift_k": _w((lambda *s: torch.randn(*s, dtype=torch.bfloat16) * 0.4)(D, ks) * 0.5),
            "ssm_k": _w((lambda *s: torch.randn(*s, dtype=torch.bfloat16) * 1.6)(D, S) * (1.0 / S ** 0.5)),
            "ssm_D": _w((lambda *s: torch.randn(*s, dtype=torch.bfloat16) * 0.4)(D)),
        }
    _A_in = _A_setup()

    def _B_setup():
        B, S, D, F, C = 1, 2048, 640, 1728, 2
        return {
            "x": _w((lambda *s: torch.randn(*s, dtype=torch.bfloat16) * 0.05)(B, S, D)),
            "w_r": _w((lambda *s: torch.randn(*s, dtype=torch.bfloat16) * 0.05)(D)),
            "w_gate": _w((lambda *s: torch.randn(*s, dtype=torch.bfloat16) * 0.05)(D, F)),
            "w_up": _w((lambda *s: torch.randn(*s, dtype=torch.bfloat16) * 0.05)(D, F)),
            "w_down": _w((lambda *s: torch.randn(*s, dtype=torch.bfloat16) * 0.05)(F, D)),
        }
    _B_in = _B_setup()

    return {
        "A_q": _A_in["q"],
        "A_k": _A_in["k"],
        "A_v": _A_in["v"],
        "A_shift_k": _A_in["shift_k"],
        "A_ssm_k": _A_in["ssm_k"],
        "A_ssm_D": _A_in["ssm_D"],
        "B_x": _B_in["x"],
        "B_w_r": _B_in["w_r"],
        "B_w_gate": _B_in["w_gate"],
        "B_w_up": _B_in["w_up"],
        "B_w_down": _B_in["w_down"],
    }

def reference(A_q, A_k, A_v, A_shift_k, A_ssm_k, A_ssm_D, B_x, B_w_r, B_w_gate, B_w_up, B_w_down):
    def _A_ref(q, k, v, shift_k, ssm_k, ssm_D):
        B, S, D = q.shape
        ks = shift_k.shape[-1]
        k_pad = _pad(k, ((0, 0), (ks - 1, 0), (0, 0)))
        k_shift = torch.zeros_like(k)
        for t in range(ks):
            k_shift = k_shift + k_pad[:, t:t + S, :] * shift_k[:, ks - 1 - t][None, None, :]
        kv = k_shift * v
        L = 2 * S
        kv_pad = _pad(kv, ((0, 0), (0, S), (0, 0)))
        kf_pad = _pad(ssm_k, ((0, 0), (0, S)))
        kv_f = (lambda x, axes=(-2,-1): torch.fft.rfft2(x.float(), dim=axes))(kv_pad[:, None, :, :], axes=(1, 2))
        kf_f = (lambda x, axes=(-2,-1): torch.fft.rfft2(x.float(), dim=axes))(kf_pad[:, None, :], axes=(1, 2))
        kf_f = (lambda x, *d: x.permute(*d))(kf_f, 1, 2, 0)
        y_f = kv_f * kf_f[None, :, :, :]
        y = (lambda x, s, axes=(-2,-1): torch.fft.irfft2(x, s=s, dim=axes).to(torch.bfloat16))(y_f, (1, L), axes=(1, 2))[:, 0, :S, :]
        y = y + kv * ssm_D[None, None, :]
        return q * y

    def _B_ref(x, w_r, w_gate, w_up, w_down):
        B, S, D = x.shape
        C = 2
        r = x @ w_r
        idx = torch.argsort(-r, axis=-1)[:, :C]
        idx_e = (lambda x, n, axis: torch.repeat_interleave(x, n, dim=axis))(idx.reshape(B, C, 1), D, axis=2)
        x_sel = (lambda x, i, axis: torch.take_along_dim(x, i, dim=axis))(x, idx_e, axis=1)
        g = _silu(x_sel @ w_gate)
        u = x_sel @ w_up
        y = (g * u) @ w_down
        r_sel = _sigmoid((lambda x, i, axis: torch.take_along_dim(x, i, dim=axis))(r, idx, axis=1))
        y = y * r_sel.reshape(B, C, 1)
        b_off = (torch.arange(B) * S).reshape(B, 1)
        flat_idx = (idx + b_off).reshape(B * C)
        zero = (x * 0.0).reshape(B * S, D)
        upd = _scatter_add(zero, flat_idx, y.reshape(B * C, D), axis=0)
        return x + upd.reshape(B, S, D)

    x = A_q
    xn = _layernorm(x, axis=-1)
    return x + _A_ref(xn, A_k, A_v, A_shift_k, A_ssm_k, A_ssm_D) + _B_ref(xn, B_w_r, B_w_gate, B_w_up, B_w_down)
```

```asm
; @launch grid=(256,1,1) block=(512,1,1) lds=112048
.amdgcn_target "amdgcn-amd-amdhsa--gfx950"
.text
.globl parallel_sum__ssm_conv_h3__moe_arch_mod__prompt_kernel
.p2align 8
.type parallel_sum__ssm_conv_h3__moe_arch_mod__prompt_kernel,@function
parallel_sum__ssm_conv_h3__moe_arch_mod__prompt_kernel:
L_start:
    s_load_dwordx16 s[4:19], s[0:1], 0
    s_load_dwordx4 s[28:31], s[0:1], 96
    s_getpc_b64 s[66:67]
    s_cmp_ge_u32 s2, 256
    s_cbranch_scc1 L_end
    s_load_dwordx8 s[20:27], s[0:1], 64
    v_lshrrev_b32 v2, 6, v0
    s_and_b32 s41, s2, 7
    v_readfirstlane_b32 s40, v2
    s_lshr_b32 s42, s2, 3
    s_lshl_b32 s43, s41, 5
    s_add_u32 s43, s43, s42
    s_mul_i32 s3, s43, 10240
    v_and_b32 v1, 63, v0
    v_lshlrev_b32 v5, 4, v1
    v_lshlrev_b32 v6, 2, v1
    s_mov_b32 s50, 2621440
    s_mov_b32 s51, 0x20000
    s_mov_b64 s[54:55], s[50:51]
    s_mov_b64 s[34:35], s[50:51]
    s_cmp_ge_u32 s40, 6
    s_cbranch_scc1 L_hiw
    v_lshrrev_b32 v2, 4, v1
    v_mul_u32_u24 v2, 1024, v2
    s_mul_i32 s61, s40, 216
    s_add_u32 s61, s61, s3
    v_add3_u32 v11, v2, v5, s61
    v_subrev_u32 v8, 3840, v11
    v_add_u32 v9, 1280, v11
    s_mul_i32 s60, s40, 5120
    s_add_u32 s60, s60, 63744
    s_mov_b32 m0, s60
    s_movk_i32 s61, 5120
    s_add_u32 s62, s60, 1024
    s_mov_b32 exec_lo, 0x3fff3fff
    s_mov_b32 exec_hi, 0x3fff3fff
    s_waitcnt lgkmcnt(0)
    s_mov_b64 s[48:49], s[6:7]
    s_mov_b64 s[52:53], s[8:9]
    buffer_load_dwordx4 v8, s[48:51], 0 offen lds
    s_mov_b32 m0, s62
    s_addk_i32 s62, 1024
    buffer_load_dwordx4 v9, s[48:51], 0 offen lds
    s_mov_b32 m0, s62
    s_addk_i32 s62, 1024
    s_movk_i32 exec_hi, 0x3fff
    buffer_load_dwordx4 v9, s[48:51], s61 offen lds
    s_mov_b32 exec_hi, exec_lo
    s_mov_b32 m0, s62
    s_addk_i32 s62, 1024
    buffer_load_dwordx4 v11, s[52:55], 0 offen lds
    s_mov_b32 m0, s62
    s_mov_b64 s[48:49], s[10:11]
    buffer_load_dwordx4 v11, s[52:55], s61 offen lds
    s_mov_b64 exec, -1
    s_movk_i32 s50, 5120
    s_mul_i32 s62, s40, 864
    buffer_load_dwordx4 v[16:19], v5, s[48:51], s62 offen
    s_barrier
    s_branch L_locont
L_hiw:
    s_lshl_b32 s60, s42, 1
    s_add_u32 s60, s60, s40
    s_sub_u32 s60, s60, 6
    s_lshl_b32 s60, s60, 7
    v_lshl_add_u32 v2, v1, 13, s60
    v_min_u32 v2, L_end-L_start-32, v2
    s_mov_b64 exec, 7
    global_load_dword v180, v2, s[66:67]
    s_mov_b64 exec, -1
    s_sub_u32 s46, s40, 6
    s_lshl_b32 s46, s46, 2
    s_mul_i32 s60, s46, 1280
    s_add_u32 s60, s60, s3
    s_add_u32 s61, s60, 2560
    v_mov_b32 v2, 0
    v_add_u32 v3, 101776, v6
    s_mov_b64 exec, 0xff
    ds_write_b32 v3, v2
    s_mov_b64 exec, -1
    s_movk_i32 s50, 1280
    s_mov_b32 s62, 7029760
    s_waitcnt lgkmcnt(0)
    s_load_dword s45, s[30:31], s62
    s_mov_b64 s[32:33], s[4:5]
    s_mov_b64 s[48:49], s[18:19]
    s_barrier
    buffer_load_dwordx4 v[8:11], v5, s[32:35], s60 offen offset:0
    buffer_load_dword v12, v6, s[32:35], s60 offen offset:1024
    buffer_load_dwordx4 v[16:19], v5, s[32:35], s60 offen offset:1280
    buffer_load_dword v20, v6, s[32:35], s60 offen offset:2304
    buffer_load_dwordx4 v[24:27], v5, s[32:35], s61 offen offset:0
    buffer_load_dword v28, v6, s[32:35], s61 offen offset:1024
    buffer_load_dwordx4 v[32:35], v5, s[32:35], s61 offen offset:1280
    buffer_load_dword v36, v6, s[32:35], s61 offen offset:2304
    buffer_load_dwordx4 v[40:43], v5, s[48:51], 0 offen
    buffer_load_dword v44, v6, s[48:51], 0 offen offset:1024
    s_branch L_ln
L_locont:
    s_mul_i32 s44, s41, 27
    s_add_u32 s44, s44, s42
    s_mul_i32 s69, s44, 3
    s_cmp_ge_u32 s44, 214
    s_cselect_b32 s47, 2, 0
    s_lshl_b32 s63, s41, 2
    s_add_u32 s63, s63, s42
    s_sub_u32 s63, s63, 27
    s_cmp_ge_u32 s63, 27
    s_cselect_b32 s64, 2, 1
    s_cmp_eq_u32 s42, 31
    s_cselect_b32 s64, 2, s64
    s_cmp_ge_u32 s42, 27
    s_cselect_b32 s47, s64, s47
    s_cselect_b32 s44, s63, s44
    s_mov_b32 s48, s14
    s_mov_b32 s49, s15
    s_mov_b32 s50, 1280
    s_mov_b32 s51, 0x20000
    s_mov_b32 s36, s30
    s_mov_b32 s37, s31
    s_mov_b32 s38, 7339136
    s_mov_b32 s39, 0x20000
    s_mov_b64 s[32:33], s[4:5]
    s_add_u32 s63, s69, s40
    s_lshl_b32 s63, s63, 1
    v_mov_b32 v3, s63
    buffer_load_ushort v7, v3, s[48:51], 0 offen
    s_mul_i32 s62, s43, 13696
    s_mul_i32 s63, s40, 2304
    s_add_u32 s62, s62, s63
    v_add_u32 v12, s62, v5
    s_cmp_eq_u32 s40, 5
    s_cselect_b32 s63, 8, 16
    v_cmp_gt_u32 vcc, s63, v1
    v_mov_b32 v3, 0x7fff0000
    v_add_u32 v15, s60, v6
    v_cndmask_b32 v13, v3, v12, vcc
    v_mul_u32_u24 v14, 12, v1
    v_add_u32 v14, s60, v14
    v_lshrrev_b32 v2, 2, v0
    v_mul_u32_u24 v191, 13696, v2
    v_and_b32 v2, 3, v0
    v_lshl_add_u32 v191, v2, 4, v191
    s_lshl_b32 s64, s44, 6
    v_add_u32 v191, s64, v191
    s_cmp_eq_u32 s40, 3
    s_cselect_b32 s62, 0, s40
    s_cselect_b32 s63, 6, 0
    v_and_b32 v8, 15, v1
    v_lshrrev_b32 v9, 4, v1
    v_lshlrev_b32 v3, 3, v9
    v_sub_u32 v3, v8, v3
    v_add_u32 v3, 25, v3
    v_sub_u32 v2, 16, v3
    v_and_b32 v4, 1, v2
    v_lshlrev_b32 v4, 4, v4
    v_mov_b32 v190, 0xffff
    v_lshlrev_b32 v190, v4, v190
    v_ashrrev_i32 v2, 1, v2
    v_cmp_eq_u32 vcc, 0, v2
    s_nop 1
    v_cndmask_b32 v184, 0, v190, vcc
    v_cmp_eq_u32 vcc, 1, v2
    s_nop 1
    v_cndmask_b32 v185, 0, v190, vcc
    v_cmp_eq_u32 vcc, 2, v2
    s_nop 1
    v_cndmask_b32 v186, 0, v190, vcc
    v_cmp_eq_u32 vcc, 3, v2
    s_nop 1
    v_cndmask_b32 v187, 0, v190, vcc
    v_and_b32 v4, 3, v3
    v_sub_u32 v3, v3, v4
    v_mul_u32_u24 v4, 4160, v4
    v_lshl_add_u32 v188, v3, 1, v4
    s_mul_i32 s61, s62, 16640
    s_lshl_b32 s64, s63, 6
    s_add_u32 s61, s61, s64
    v_add_u32 v188, s61, v188
    v_lshl_add_u32 v3, v8, 1, v9
    v_mul_u32_u24 v189, 48, v3
    s_lshl_b32 s61, s62, 4
    s_add_u32 s61, s61, 51168
    s_mul_i32 s64, s63, 192
    s_sub_u32 s61, s61, s64
    v_add_u32 v189, s61, v189
    v_lshrrev_b32 v3, 1, v9
    v_mul_u32_u24 v3, 48, v3
    v_and_b32 v4, 1, v9
    v_mul_u32_u24 v190, 104, v8
    v_add_u32 v190, v190, v3
    v_lshl_add_u32 v190, v4, 3, v190
    s_lshl_b32 s61, s62, 4
    s_add_u32 s61, s61, 88320
    v_add_u32 v190, s61, v190
    s_lshl_b32 s64, s62, 13
    s_add_u32 s64, s64, 63744
    v_add_u32 v192, s64, v5
    s_lshl_b32 s61, s62, 2
    s_add_u32 s61, s61, 101776
    v_mov_b32 v193, s61
    v_add_u32 v195, 2048, v188
    v_mul_u32_u24 v194, 12, v0
    v_add_u32 v194, 51456, v194
    v_mov_b32 v10, 101776
    v_lshl_add_u32 v11, v5, 1, s60
L_lw_1:
    ds_read_b32 v2, v10 offset:12
    s_waitcnt lgkmcnt(0)
    v_cmp_gt_u32 vcc, 1, v2
    s_cbranch_vccnz L_lw_1
    v_readfirstlane_b32 s45, v2
    s_setprio 1
    s_mov_b32 s52, s12
    s_mov_b32 s53, s13
    s_mov_b32 s54, 2621440
    s_mov_b32 s55, 0x20000
    s_lshl_b32 s61, s40, 10
    s_lshl_b32 s62, s69, 12
    s_add_u32 s62, s62, s61
    s_add_u32 s61, s61, 32
    s_mov_b32 m0, s61
    s_cmp_lt_u32 s40, 4
    s_cselect_b32 s65, s47, 1
    s_cmp_lg_u32 s65, 0
    s_waitcnt vmcnt(1)
    s_cbranch_scc1 L_noh
    buffer_load_dwordx4 v5, s[52:55], s62 offen lds
    s_add_u32 s61, s61, 8320
    s_mov_b32 m0, s61
    s_add_u32 s62, s62, 4
    buffer_load_dwordx4 v5, s[52:55], s62 offen lds
    s_add_u32 s61, s61, 8320
    s_mov_b32 m0, s61
    s_add_u32 s62, s62, 4092
    buffer_load_dwordx4 v5, s[52:55], s62 offen lds
    s_add_u32 s61, s61, 8320
    s_mov_b32 m0, s61
    s_add_u32 s62, s62, 4
    buffer_load_dwordx4 v5, s[52:55], s62 offen lds
    s_add_u32 s61, s61, 8320
    s_mov_b32 m0, s61
    s_add_u32 s62, s62, 4092
    buffer_load_dwordx4 v5, s[52:55], s62 offen lds
    s_add_u32 s61, s61, 8320
    s_mov_b32 m0, s61
    s_add_u32 s62, s62, 4
    buffer_load_dwordx4 v5, s[52:55], s62 offen lds
    s_waitcnt vmcnt(7)
    s_branch L_kvok
L_noh:
    s_waitcnt vmcnt(1)
L_kvok:
L_ustart:
    ds_read2st64_b32 v[20:21], v15 offset0:0 offset1:1
    ds_read2st64_b32 v[22:23], v15 offset0:2 offset1:3
    ds_read2st64_b32 v[24:25], v15 offset0:4 offset1:5
    ds_read2st64_b32 v[26:27], v15 offset0:6 offset1:7
    ds_read2st64_b32 v[28:29], v15 offset0:8 offset1:9
    ds_read2st64_b32 v[30:31], v15 offset0:10 offset1:11
    ds_read2st64_b32 v[32:33], v15 offset0:12 offset1:13
    ds_read2st64_b32 v[34:35], v15 offset0:14 offset1:15
    ds_read2st64_b32 v[36:37], v15 offset0:16 offset1:17
    ds_read2st64_b32 v[38:39], v15 offset0:18 offset1:19
    v_lshlrev_b32 v62, 16, v16
    v_lshlrev_b32 v63, 16, v18
    v_and_b32 v64, 0xffff0000, v16
    v_and_b32 v65, 0xffff0000, v18
    v_lshlrev_b32 v66, 16, v17
    v_lshlrev_b32 v67, 16, v19
    v_and_b32 v68, 0xffff0000, v17
    v_and_b32 v69, 0xffff0000, v19
    s_waitcnt lgkmcnt(4)
    v_lshlrev_b32 v40, 16, v20
    v_and_b32 v41, 0xffff0000, v20
    v_lshlrev_b32 v42, 16, v21
    v_and_b32 v43, 0xffff0000, v21
    v_lshlrev_b32 v44, 16, v22
    v_and_b32 v45, 0xffff0000, v22
    v_lshlrev_b32 v46, 16, v23
    v_and_b32 v47, 0xffff0000, v23
    v_lshlrev_b32 v48, 16, v24
    v_and_b32 v49, 0xffff0000, v24
    v_lshlrev_b32 v50, 16, v25
    v_and_b32 v51, 0xffff0000, v25
    v_lshlrev_b32 v52, 16, v26
    v_and_b32 v53, 0xffff0000, v26
    v_lshlrev_b32 v54, 16, v27
    v_and_b32 v55, 0xffff0000, v27
    v_lshlrev_b32 v56, 16, v28
    v_and_b32 v57, 0xffff0000, v28
    v_lshlrev_b32 v58, 16, v29
    v_and_b32 v59, 0xffff0000, v29
    v_lshlrev_b32 v60, 16, v30
    v_and_b32 v61, 0xffff0000, v30
    v_pk_mul_f32 v[72:73], v[40:41], v[68:69]
    v_pk_mul_f32 v[74:75], v[42:43], v[68:69]
    v_pk_mul_f32 v[76:77], v[44:45], v[68:69]
    v_pk_mul_f32 v[78:79], v[46:47], v[68:69]
    v_pk_mul_f32 v[80:81], v[48:49], v[68:69]
    v_pk_mul_f32 v[82:83], v[50:51], v[68:69]
    v_pk_mul_f32 v[84:85], v[52:53], v[68:69]
    v_pk_mul_f32 v[86:87], v[54:55], v[68:69]
    v_pk_fma_f32 v[72:73], v[42:43], v[66:67], v[72:73]
    v_pk_fma_f32 v[74:75], v[44:45], v[66:67], v[74:75]
    v_pk_fma_f32 v[76:77], v[46:47], v[66:67], v[76:77]
    v_pk_fma_f32 v[78:79], v[48:49], v[66:67], v[78:79]
    v_pk_fma_f32 v[80:81], v[50:51], v[66:67], v[80:81]
    v_pk_fma_f32 v[82:83], v[52:53], v[66:67], v[82:83]
    v_pk_fma_f32 v[84:85], v[54:55], v[66:67], v[84:85]
    v_pk_fma_f32 v[86:87], v[56:57], v[66:67], v[86:87]
    v_pk_fma_f32 v[72:73], v[44:45], v[64:65], v[72:73]
    v_pk_fma_f32 v[74:75], v[46:47], v[64:65], v[74:75]
    v_pk_fma_f32 v[76:77], v[48:49], v[64:65], v[76:77]
    v_pk_fma_f32 v[78:79], v[50:51], v[64:65], v[78:79]
    v_pk_fma_f32 v[80:81], v[52:53], v[64:65], v[80:81]
    v_pk_fma_f32 v[82:83], v[54:55], v[64:65], v[82:83]
    v_pk_fma_f32 v[84:85], v[56:57], v[64:65], v[84:85]
    v_pk_fma_f32 v[86:87], v[58:59], v[64:65], v[86:87]
    v_pk_fma_f32 v[72:73], v[46:47], v[62:63], v[72:73]
    v_pk_fma_f32 v[74:75], v[48:49], v[62:63], v[74:75]
    v_pk_fma_f32 v[76:77], v[50:51], v[62:63], v[76:77]
    v_pk_fma_f32 v[78:79], v[52:53], v[62:63], v[78:79]
    v_pk_fma_f32 v[80:81], v[54:55], v[62:63], v[80:81]
    v_pk_fma_f32 v[82:83], v[56:57], v[62:63], v[82:83]
    v_pk_fma_f32 v[84:85], v[58:59], v[62:63], v[84:85]
    v_pk_fma_f32 v[86:87], v[60:61], v[62:63], v[86:87]
    s_waitcnt lgkmcnt(0)
    v_lshlrev_b32 v40, 16, v32
    v_and_b32 v41, 0xffff0000, v32
    v_lshlrev_b32 v42, 16, v33
    v_and_b32 v43, 0xffff0000, v33
    v_lshlrev_b32 v44, 16, v34
    v_and_b32 v45, 0xffff0000, v34
    v_lshlrev_b32 v46, 16, v35
    v_and_b32 v47, 0xffff0000, v35
    v_lshlrev_b32 v48, 16, v36
    v_and_b32 v49, 0xffff0000, v36
    v_lshlrev_b32 v50, 16, v37
    v_and_b32 v51, 0xffff0000, v37
    v_lshlrev_b32 v52, 16, v38
    v_and_b32 v53, 0xffff0000, v38
    v_lshlrev_b32 v54, 16, v39
    v_and_b32 v55, 0xffff0000, v39
    v_pk_mul_f32 v[72:73], v[72:73], v[40:41]
    v_pk_mul_f32 v[74:75], v[74:75], v[42:43]
    v_pk_mul_f32 v[76:77], v[76:77], v[44:45]
    v_pk_mul_f32 v[78:79], v[78:79], v[46:47]
    v_pk_mul_f32 v[80:81], v[80:81], v[48:49]
    v_pk_mul_f32 v[82:83], v[82:83], v[50:51]
    v_pk_mul_f32 v[84:85], v[84:85], v[52:53]
    v_pk_mul_f32 v[86:87], v[86:87], v[54:55]
    v_cvt_pk_bf16_f32 v40, v86, v84
    v_cvt_pk_bf16_f32 v41, v82, v80
    v_cvt_pk_bf16_f32 v42, v78, v76
    v_cvt_pk_bf16_f32 v43, v74, v72
    ds_write_b128 v11, v[40:43] offset:0
    v_cvt_pk_bf16_f32 v44, v87, v85
    v_cvt_pk_bf16_f32 v45, v83, v81
    v_cvt_pk_bf16_f32 v46, v79, v77
    v_cvt_pk_bf16_f32 v47, v75, v73
    ds_write_b128 v11, v[44:47] offset:16
    ds_read2_b32 v[72:73], v14 offset0:0 offset1:1
    ds_read_b32 v74, v14 offset:8
    ds_read2_b32 v[76:77], v14 offset0:192 offset1:193
    ds_read_b32 v78, v14 offset:776
    ds_read_b32 v80, v14 offset:1536
    ds_read_b32 v81, v14 offset:1540
    ds_read_b32 v82, v14 offset:1544
    v_mov_b32 v75, s45
    v_mov_b32 v79, s45
    v_mov_b32 v83, s45
    s_waitcnt lgkmcnt(5)
    buffer_store_dwordx4 v[72:75], v12, s[36:39], 0 offen sc1
    s_waitcnt lgkmcnt(3)
    buffer_store_dwordx4 v[76:79], v12, s[36:39], 0 offen offset:1024 sc1
    s_waitcnt lgkmcnt(0)
    buffer_store_dwordx4 v[80:83], v13, s[36:39], 0 offen offset:2048 sc1
    s_setprio 0
    s_cmp_lg_u32 s47, 0
    s_cbranch_scc1 L_nonconv
    s_cmp_lt_u32 s40, 4
    s_cbranch_scc1 L_w03
    v_mov_b32 v3, 1
    s_cmp_lt_u32 s44, 144
    s_cbranch_scc1 L_w45s
    s_waitcnt vmcnt(0)
L_w45s:
    s_mov_b64 exec, 1
    ds_add_u32 v10, v3 offset:24
    s_mov_b64 exec, -1
    s_branch L_xwait
L_w03:
    s_cmp_eq_u32 s40, 3
    s_cbranch_scc1 L_helper
    s_waitcnt vmcnt(9)
    v_lshl_or_b32 v7, v7, 16, v7
    v_and_b32 v184, v7, v184
    v_and_b32 v185, v7, v185
    v_and_b32 v186, v7, v186
    v_and_b32 v187, v7, v187
    v_subrev_u32 v199, 1152, v189
    v_lshrrev_b32 v2, 3, v0
    v_and_b32 v4, 7, v0
    v_mul_u32_u24 v196, 104, v2
    v_mad_u32_u24 v196, v4, 12, v196
    v_add_u32 v196, 88320, v196
    v_add_u32 v198, 6656, v196
    v_mul_u32_u24 v197, 27392, v2
    v_lshl_add_u32 v197, v4, 4, v197
    s_lshl_b32 s56, s44, 7
    s_add_u32 s56, s56, 3506176
    s_add_u32 s57, s56, 1753088
    v_mov_b32 v203, s45
    v_mov_b32 v207, s45
    v_mov_b32 v3, 1
    s_waitcnt vmcnt(0)
    s_mov_b64 exec, 1
    ds_add_u32 v10, v3 offset:24
    s_mov_b64 exec, -1
L_lw_2:
    ds_read_b32 v2, v10 offset:24
    s_waitcnt lgkmcnt(0)
    v_cmp_gt_u32 vcc, 6, v2
    s_cbranch_vccnz L_lw_2
    s_mov_b32 s68, 200000
    s_mov_b64 s[66:67], exec
    s_mov_b32 s65, 0
    buffer_load_dwordx4 v[136:139], v191, s[36:39], s65 offen sc1
    s_mov_b32 s65, 876544
    buffer_load_dwordx4 v[140:143], v191, s[36:39], s65 offen sc1
    s_mov_b32 s65, 1753088
    buffer_load_dwordx4 v[144:147], v191, s[36:39], s65 offen sc1
    s_mov_b32 s65, 2629632
    buffer_load_dwordx4 v[148:151], v191, s[36:39], s65 offen sc1
L_lw_6:
    ds_read_b32 v2, v10 offset:20
    s_waitcnt lgkmcnt(0)
    v_cmp_gt_u32 vcc, 4, v2
    s_cbranch_vccnz L_lw_6
    ds_read_b64 v[40:41], v188 offset:0
    ds_read_b64 v[42:43], v188 offset:8
    ds_read_b64 v[44:45], v188 offset:512
    ds_read_b64 v[46:47], v188 offset:520
    ds_read_b64 v[48:49], v188 offset:1024
    ds_read_b64 v[50:51], v188 offset:1032
    ds_read_b64 v[52:53], v188 offset:1536
    ds_read_b64 v[54:55], v188 offset:1544
    ds_read_b64 v[56:57], v188 offset:2048
    ds_read_b64 v[58:59], v188 offset:2056
    ds_read_b64 v[60:61], v188 offset:2560
    ds_read_b64 v[62:63], v188 offset:2568
    ds_read_b64 v[64:65], v188 offset:3072
    ds_read_b64 v[66:67], v188 offset:3080
    ds_read_b64 v[68:69], v188 offset:3584
    ds_read_b64 v[70:71], v188 offset:3592
    ds_read_b64 v[208:209], v188 offset:448
    ds_read_b64 v[210:211], v188 offset:456
    ds_read_b64 v[212:213], v188 offset:960
    ds_read_b64 v[214:215], v188 offset:968
    s_branch L_pollm_5
L_poll_3:
    s_mov_b32 s65, 0
    buffer_load_dwordx4 v[136:139], v191, s[36:39], s65 offen sc1
    s_mov_b32 s65, 876544
    buffer_load_dwordx4 v[140:143], v191, s[36:39], s65 offen sc1
    s_mov_b32 s65, 1753088
    buffer_load_dwordx4 v[144:147], v191, s[36:39], s65 offen sc1
    s_mov_b32 s65, 2629632
    buffer_load_dwordx4 v[148:151], v191, s[36:39], s65 offen sc1
L_pollm_5:
    s_waitcnt vmcnt(3)
    ds_write_b32 v194, v136 offset:0
    ds_write_b32 v194, v137 offset:4
    ds_write_b32 v194, v138 offset:8
    s_waitcnt vmcnt(2)
    ds_write_b32 v194, v140 offset:3072
    ds_write_b32 v194, v141 offset:3076
    ds_write_b32 v194, v142 offset:3080
    s_waitcnt vmcnt(1)
    ds_write_b32 v194, v144 offset:6144
    ds_write_b32 v194, v145 offset:6148
    ds_write_b32 v194, v146 offset:6152
    s_waitcnt vmcnt(0)
    ds_write_b32 v194, v148 offset:9216
    ds_write_b32 v194, v149 offset:9220
    ds_write_b32 v194, v150 offset:9224
    v_cmpx_eq_u32 vcc, s45, v139
    v_cmpx_eq_u32 vcc, s45, v143
    v_cmpx_eq_u32 vcc, s45, v147
    v_cmpx_eq_u32 vcc, s45, v151
    s_andn2_b64 s[66:67], s[66:67], exec
    s_cbranch_scc0 L_pollx_4
    s_mov_b64 exec, s[66:67]
    s_sub_u32 s68, s68, 1
    s_sleep 1
    s_cmp_lg_u32 s68, 0
    s_cbranch_scc1 L_poll_3
L_pollx_4:
    s_mov_b64 exec, -1
    s_waitcnt lgkmcnt(0)
    s_barrier
    s_mov_b32 s64, 0
L_ownstart:
    ds_read_b128 v[104:107], v189 offset:192
    ds_read_b128 v[108:111], v189 offset:1728
    ds_read_b128 v[112:115], v189 offset:3264
    ds_read_b128 v[116:119], v189 offset:4800
    ds_read_b128 v[120:123], v189 offset:6336
    ds_read_b128 v[124:127], v189 offset:7872
    ds_read_b128 v[128:131], v189 offset:9408
    ds_read_b128 v[132:135], v189 offset:10944
    ds_read_b128 v[216:219], v199
    ds_read_b128 v[220:223], v199 offset:1536
    s_waitcnt lgkmcnt(9)
    v_mfma_f32_16x16x32_bf16 v[8:11], v[184:187], v[104:107], 0
    s_waitcnt lgkmcnt(8)
    v_mfma_f32_16x16x32_bf16 v[12:15], v[184:187], v[108:111], 0
    s_waitcnt lgkmcnt(7)
    v_mfma_f32_16x16x32_bf16 v[16:19], v[184:187], v[112:115], 0
    s_waitcnt lgkmcnt(6)
    v_mfma_f32_16x16x32_bf16 v[20:23], v[184:187], v[116:119], 0
    s_waitcnt lgkmcnt(5)
    v_mfma_f32_16x16x32_bf16 v[24:27], v[184:187], v[120:123], 0
    s_waitcnt lgkmcnt(4)
    v_mfma_f32_16x16x32_bf16 v[28:31], v[184:187], v[124:127], 0
    s_waitcnt lgkmcnt(3)
    v_mfma_f32_16x16x32_bf16 v[32:35], v[184:187], v[128:131], 0
    s_waitcnt lgkmcnt(2)
    v_mfma_f32_16x16x32_bf16 v[36:39], v[184:187], v[132:135], 0
    s_waitcnt lgkmcnt(0)
    v_mfma_f32_16x16x32_bf16 v[8:11], v[208:211], v[216:219], v[8:11]
    v_mfma_f32_16x16x32_bf16 v[12:15], v[208:211], v[220:223], v[12:15]
    v_mfma_f32_16x16x32_bf16 v[12:15], v[212:215], v[216:219], v[12:15]
L_loop:
    s_waitcnt lgkmcnt(0)
    v_mfma_f32_16x16x32_bf16 v[8:11], v[40:43], v[104:107], v[8:11]
    ds_read_b64 v[72:73], v188 offset:64
    v_mfma_f32_16x16x32_bf16 v[12:15], v[40:43], v[108:111], v[12:15]
    ds_read_b64 v[74:75], v188 offset:72
    v_mfma_f32_16x16x32_bf16 v[12:15], v[44:47], v[104:107], v[12:15]
    ds_read_b128 v[136:139], v189 offset:0
    v_mfma_f32_16x16x32_bf16 v[16:19], v[44:47], v[108:111], v[16:19]
    ds_read_b64 v[76:77], v188 offset:576
    v_mfma_f32_16x16x32_bf16 v[16:19], v[40:43], v[112:115], v[16:19]
    ds_read_b64 v[78:79], v188 offset:584
    v_mfma_f32_16x16x32_bf16 v[16:19], v[48:51], v[104:107], v[16:19]
    ds_read_b128 v[140:143], v189 offset:1536
    v_mfma_f32_16x16x32_bf16 v[20:23], v[44:47], v[112:115], v[20:23]
    ds_read_b64 v[80:81], v188 offset:1088
    v_mfma_f32_16x16x32_bf16 v[20:23], v[48:51], v[108:111], v[20:23]
    ds_read_b64 v[82:83], v188 offset:1096
    v_mfma_f32_16x16x32_bf16 v[24:27], v[48:51], v[112:115], v[24:27]
    ds_read_b128 v[144:147], v189 offset:3072
    v_mfma_f32_16x16x32_bf16 v[20:23], v[40:43], v[116:119], v[20:23]
    ds_read_b64 v[84:85], v188 offset:1600
    v_mfma_f32_16x16x32_bf16 v[20:23], v[52:55], v[104:107], v[20:23]
    ds_read_b64 v[86:87], v188 offset:1608
    v_mfma_f32_16x16x32_bf16 v[24:27], v[44:47], v[116:119], v[24:27]
    ds_read_b128 v[148:151], v189 offset:4608
    v_mfma_f32_16x16x32_bf16 v[24:27], v[52:55], v[108:111], v[24:27]
    ds_read_b64 v[88:89], v188 offset:2112
    v_mfma_f32_16x16x32_bf16 v[28:31], v[48:51], v[116:119], v[28:31]
    ds_read_b64 v[90:91], v188 offset:2120
    v_mfma_f32_16x16x32_bf16 v[28:31], v[52:55], v[112:115], v[28:31]
    ds_read_b128 v[152:155], v189 offset:6144
    v_mfma_f32_16x16x32_bf16 v[32:35], v[52:55], v[116:119], v[32:35]
    ds_read_b64 v[92:93], v188 offset:2624
    v_mfma_f32_16x16x32_bf16 v[24:27], v[40:43], v[120:123], v[24:27]
    ds_read_b64 v[94:95], v188 offset:2632
    v_mfma_f32_16x16x32_bf16 v[24:27], v[56:59], v[104:107], v[24:27]
    ds_read_b128 v[156:159], v189 offset:7680
    v_mfma_f32_16x16x32_bf16 v[28:31], v[44:47], v[120:123], v[28:31]
    ds_read_b64 v[96:97], v188 offset:3136
    v_mfma_f32_16x16x32_bf16 v[28:31], v[56:59], v[108:111], v[28:31]
    ds_read_b64 v[98:99], v188 offset:3144
    v_mfma_f32_16x16x32_bf16 v[32:35], v[48:51], v[120:123], v[32:35]
    ds_read_b128 v[160:163], v189 offset:9216
    v_mfma_f32_16x16x32_bf16 v[32:35], v[56:59], v[112:115], v[32:35]
    ds_read_b64 v[100:101], v188 offset:3648
    v_mfma_f32_16x16x32_bf16 v[36:39], v[52:55], v[120:123], v[36:39]
    ds_read_b64 v[102:103], v188 offset:3656
    v_mfma_f32_16x16x32_bf16 v[36:39], v[56:59], v[116:119], v[36:39]
    ds_read_b128 v[164:167], v189 offset:10752
    v_mfma_f32_16x16x32_bf16 v[28:31], v[40:43], v[124:127], v[28:31]
    v_mfma_f32_16x16x32_bf16 v[28:31], v[60:63], v[104:107], v[28:31]
    v_mfma_f32_16x16x32_bf16 v[32:35], v[44:47], v[124:127], v[32:35]
    v_mfma_f32_16x16x32_bf16 v[32:35], v[60:63], v[108:111], v[32:35]
    v_mfma_f32_16x16x32_bf16 v[36:39], v[48:51], v[124:127], v[36:39]
    v_mfma_f32_16x16x32_bf16 v[36:39], v[60:63], v[112:115], v[36:39]
    v_mfma_f32_16x16x32_bf16 v[32:35], v[40:43], v[128:131], v[32:35]
    v_mfma_f32_16x16x32_bf16 v[32:35], v[64:67], v[104:107], v[32:35]
    v_mfma_f32_16x16x32_bf16 v[36:39], v[44:47], v[128:131], v[36:39]
    v_mfma_f32_16x16x32_bf16 v[36:39], v[64:67], v[108:111], v[36:39]
    v_add_u32 v188, 128, v188
    v_subrev_u32 v189, 384, v189
    v_mfma_f32_16x16x32_bf16 v[36:39], v[40:43], v[132:135], v[36:39]
    v_mfma_f32_16x16x32_bf16 v[36:39], v[68:71], v[104:107], v[36:39]
    s_waitcnt lgkmcnt(0)
    v_mfma_f32_16x16x32_bf16 v[8:11], v[72:75], v[136:139], v[8:11]
    ds_read_b64 v[40:41], v188 offset:0
    v_mfma_f32_16x16x32_bf16 v[12:15], v[72:75], v[140:143], v[12:15]
    ds_read_b64 v[42:43], v188 offset:8
    v_mfma_f32_16x16x32_bf16 v[12:15], v[76:79], v[136:139], v[12:15]
    ds_read_b128 v[104:107], v189 offset:192
    v_mfma_f32_16x16x32_bf16 v[16:19], v[76:79], v[140:143], v[16:19]
    ds_read_b64 v[44:45], v188 offset:512
    v_mfma_f32_16x16x32_bf16 v[16:19], v[72:75], v[144:147], v[16:19]
    ds_read_b64 v[46:47], v188 offset:520
    v_mfma_f32_16x16x32_bf16 v[16:19], v[80:83], v[136:139], v[16:19]
    ds_read_b128 v[108:111], v189 offset:1728
    v_mfma_f32_16x16x32_bf16 v[20:23], v[76:79], v[144:147], v[20:23]
    ds_read_b64 v[48:49], v188 offset:1024
    v_mfma_f32_16x16x32_bf16 v[20:23], v[80:83], v[140:143], v[20:23]
    ds_read_b64 v[50:51], v188 offset:1032
    v_mfma_f32_16x16x32_bf16 v[24:27], v[80:83], v[144:147], v[24:27]
    ds_read_b128 v[112:115], v189 offset:3264
    v_mfma_f32_16x16x32_bf16 v[20:23], v[72:75], v[148:151], v[20:23]
    ds_read_b64 v[52:53], v188 offset:1536
    v_mfma_f32_16x16x32_bf16 v[20:23], v[84:87], v[136:139], v[20:23]
    ds_read_b64 v[54:55], v188 offset:1544
    v_mfma_f32_16x16x32_bf16 v[24:27], v[76:79], v[148:151], v[24:27]
    ds_read_b128 v[116:119], v189 offset:4800
    v_mfma_f32_16x16x32_bf16 v[24:27], v[84:87], v[140:143], v[24:27]
    ds_read_b64 v[56:57], v188 offset:2048
    v_mfma_f32_16x16x32_bf16 v[28:31], v[80:83], v[148:151], v[28:31]
    ds_read_b64 v[58:59], v188 offset:2056
    v_mfma_f32_16x16x32_bf16 v[28:31], v[84:87], v[144:147], v[28:31]
    ds_read_b128 v[120:123], v189 offset:6336
    v_mfma_f32_16x16x32_bf16 v[32:35], v[84:87], v[148:151], v[32:35]
    ds_read_b64 v[60:61], v188 offset:2560
    v_mfma_f32_16x16x32_bf16 v[24:27], v[72:75], v[152:155], v[24:27]
    ds_read_b64 v[62:63], v188 offset:2568
    v_mfma_f32_16x16x32_bf16 v[24:27], v[88:91], v[136:139], v[24:27]
    ds_read_b128 v[124:127], v189 offset:7872
    v_mfma_f32_16x16x32_bf16 v[28:31], v[76:79], v[152:155], v[28:31]
    ds_read_b64 v[64:65], v188 offset:3072
    v_mfma_f32_16x16x32_bf16 v[28:31], v[88:91], v[140:143], v[28:31]
    ds_read_b64 v[66:67], v188 offset:3080
    v_mfma_f32_16x16x32_bf16 v[32:35], v[80:83], v[152:155], v[32:35]
    ds_read_b128 v[128:131], v189 offset:9408
    v_mfma_f32_16x16x32_bf16 v[32:35], v[88:91], v[144:147], v[32:35]
    ds_read_b64 v[68:69], v188 offset:3584
    v_mfma_f32_16x16x32_bf16 v[36:39], v[84:87], v[152:155], v[36:39]
    ds_read_b64 v[70:71], v188 offset:3592
    v_mfma_f32_16x16x32_bf16 v[36:39], v[88:91], v[148:151], v[36:39]
    ds_read_b128 v[132:135], v189 offset:10944
    v_mfma_f32_16x16x32_bf16 v[28:31], v[72:75], v[156:159], v[28:31]
    v_mfma_f32_16x16x32_bf16 v[28:31], v[92:95], v[136:139], v[28:31]
    v_mfma_f32_16x16x32_bf16 v[32:35], v[76:79], v[156:159], v[32:35]
    v_mfma_f32_16x16x32_bf16 v[32:35], v[92:95], v[140:143], v[32:35]
    v_mfma_f32_16x16x32_bf16 v[36:39], v[80:83], v[156:159], v[36:39]
    v_mfma_f32_16x16x32_bf16 v[36:39], v[92:95], v[144:147], v[36:39]
    v_mfma_f32_16x16x32_bf16 v[32:35], v[72:75], v[160:163], v[32:35]
    v_mfma_f32_16x16x32_bf16 v[32:35], v[96:99], v[136:139], v[32:35]
    v_mfma_f32_16x16x32_bf16 v[36:39], v[76:79], v[160:163], v[36:39]
    v_mfma_f32_16x16x32_bf16 v[36:39], v[96:99], v[140:143], v[36:39]
    s_add_u32 s64, s64, 1
    s_cmp_lt_u32 s64, 3
    v_mfma_f32_16x16x32_bf16 v[36:39], v[72:75], v[164:167], v[36:39]
    v_mfma_f32_16x16x32_bf16 v[36:39], v[100:103], v[136:139], v[36:39]
    s_cbranch_scc1 L_loop
    ds_read_b32 v2, v193
    s_waitcnt lgkmcnt(1)
    v_mfma_f32_16x16x32_bf16 v[8:11], v[40:43], v[104:107], v[8:11]
    v_mfma_f32_16x16x32_bf16 v[12:15], v[40:43], v[108:111], v[12:15]
    v_mfma_f32_16x16x32_bf16 v[12:15], v[44:47], v[104:107], v[12:15]
    s_waitcnt lgkmcnt(0)
    v_cmp_ne_u32 vcc, 0, v2
    s_cbranch_vccnz L_pok
L_lw_7:
    ds_read_b32 v2, v193 offset:0
    s_waitcnt lgkmcnt(0)
    v_cmp_gt_u32 vcc, 1, v2
    s_cbranch_vccnz L_lw_7
L_pok:
    ds_read_b128 v[80:83], v192 offset:2048
    ds_read_b128 v[84:87], v192 offset:3072
    ds_read_b128 v[88:91], v192 offset:4096
    ds_read_b128 v[92:95], v192 offset:5120
    ds_read_b128 v[96:99], v192 offset:6144
    ds_read_b128 v[100:103], v192 offset:7168
    v_cvt_pk_bf16_f32 v8, v8, v9
    v_cvt_pk_bf16_f32 v9, v10, v11
    ds_write_b64 v190, v[8:9] offset:0
    v_cvt_pk_bf16_f32 v12, v12, v13
    v_cvt_pk_bf16_f32 v13, v14, v15
    ds_write_b64 v190, v[12:13] offset:1664
    s_waitcnt lgkmcnt(7)
    v_pk_add_f32 v[16:17], v[16:17], v[80:81]
    v_pk_add_f32 v[18:19], v[18:19], v[82:83]
    v_cvt_pk_bf16_f32 v16, v16, v17
    v_cvt_pk_bf16_f32 v17, v18, v19
    ds_write_b64 v190, v[16:17] offset:3328
    s_waitcnt lgkmcnt(7)
    v_pk_add_f32 v[20:21], v[20:21], v[84:85]
    v_pk_add_f32 v[22:23], v[22:23], v[86:87]
    v_cvt_pk_bf16_f32 v20, v20, v21
    v_cvt_pk_bf16_f32 v21, v22, v23
    ds_write_b64 v190, v[20:21] offset:4992
    s_waitcnt lgkmcnt(7)
    v_pk_add_f32 v[24:25], v[24:25], v[88:89]
    v_pk_add_f32 v[26:27], v[26:27], v[90:91]
    v_cvt_pk_bf16_f32 v24, v24, v25
    v_cvt_pk_bf16_f32 v25, v26, v27
    ds_write_b64 v190, v[24:25] offset:6656
    s_waitcnt lgkmcnt(7)
    v_pk_add_f32 v[28:29], v[28:29], v[92:93]
    v_pk_add_f32 v[30:31], v[30:31], v[94:95]
    v_cvt_pk_bf16_f32 v28, v28, v29
    v_cvt_pk_bf16_f32 v29, v30, v31
    ds_write_b64 v190, v[28:29] offset:8320
    s_waitcnt lgkmcnt(7)
    v_pk_add_f32 v[32:33], v[32:33], v[96:97]
    v_pk_add_f32 v[34:35], v[34:35], v[98:99]
    v_cvt_pk_bf16_f32 v32, v32, v33
    v_cvt_pk_bf16_f32 v33, v34, v35
    ds_write_b64 v190, v[32:33] offset:9984
    s_waitcnt lgkmcnt(7)
    v_pk_add_f32 v[36:37], v[36:37], v[100:101]
    v_pk_add_f32 v[38:39], v[38:39], v[102:103]
    v_cvt_pk_bf16_f32 v36, v36, v37
    v_cvt_pk_bf16_f32 v37, v38, v39
    ds_write_b64 v190, v[36:37] offset:11648
L_b4join:
    s_waitcnt lgkmcnt(0)
    s_barrier
    ds_read2_b32 v[200:201], v196 offset0:0 offset1:1
    ds_read_b32 v202, v196 offset:8
    ds_read2_b32 v[204:205], v198 offset0:0 offset1:1
    ds_read_b32 v206, v198 offset:8
    s_waitcnt lgkmcnt(2)
    buffer_store_dwordx4 v[200:203], v197, s[36:39], s56 offen sc1
    s_waitcnt lgkmcnt(0)
    buffer_store_dwordx4 v[204:207], v197, s[36:39], s57 offen sc1
    s_cmp_lt_u32 s40, 3
    s_cbranch_scc1 L_done
L_p3pre:
    v_subrev_u32 v2, 192, v0
    v_lshl_add_u32 v16, v2, 2, s3
    v_lshlrev_b32 v3, 2, v2
    v_add_u32 v3, 101808, v3
    ds_read2st64_b32 v[26:27], v3 offset0:0 offset1:5
    ds_read2st64_b32 v[28:29], v3 offset0:10 offset1:15
    ds_read2st64_b32 v[30:31], v3 offset0:20 offset1:25
    ds_read2st64_b32 v[32:33], v3 offset0:30 offset1:35
    v_mov_b32 v3, 101632
    ds_read_b128 v[36:39], v3
    ds_read_b128 v[40:43], v3 offset:16
    ds_read_b128 v[44:47], v3 offset:32
    ds_read_b128 v[48:51], v3 offset:48
    s_lshl_b32 s60, s40, 6
    s_add_u32 s60, s60, 63744
    v_lshl_add_u32 v18, v2, 5, s60
    s_sub_u32 s62, s40, 3
    s_mul_i32 s62, s62, 43691
    s_lshr_b32 s62, s62, 8
    s_add_u32 s63, s62, 171
    s_lshr_b32 s64, s43, 1
    s_mul_i32 s64, s64, 27392
    s_and_b32 s65, s43, 1
    s_lshl_b32 s65, s65, 6
    s_add_u32 s64, s64, s65
    s_add_u32 s64, s64, 3506176
    v_add_u32 v3, s62, v1
    v_min_u32 v3, s63, v3
    v_and_b32 v4, 0xffc, v3
    v_add_u32 v4, v4, v3
    v_lshl_add_u32 v19, v4, 4, s64
    v_mul_u32_u24 v22, 12, v3
    v_add_u32 v22, s60, v22
    s_add_u32 s62, s62, 64
    v_add_u32 v3, s62, v1
    v_min_u32 v3, s63, v3
    v_and_b32 v4, 0xffc, v3
    v_add_u32 v4, v4, v3
    v_lshl_add_u32 v20, v4, 4, s64
    v_mul_u32_u24 v23, 12, v3
    v_add_u32 v23, s60, v23
    s_add_u32 s62, s62, 64
    v_add_u32 v3, s62, v1
    v_min_u32 v3, s63, v3
    v_and_b32 v4, 0xffc, v3
    v_add_u32 v4, v4, v3
    v_lshl_add_u32 v21, v4, 4, s64
    v_mul_u32_u24 v24, 12, v3
    v_add_u32 v24, s60, v24
    s_add_u32 s62, s62, 64
    s_lshl_b32 s62, s41, 7
    s_add_u32 s62, s62, 7028736
    v_mov_b32 v17, s62
    s_cmp_lg_u32 s47, 1
    s_cbranch_scc1 L_p3n
    buffer_load_dwordx4 v[96:99], v17, s[36:39], 0 offen sc1
    buffer_load_dwordx4 v[84:87], v19, s[36:39], 0 offen sc1
    buffer_load_dwordx4 v[88:91], v20, s[36:39], 0 offen sc1
    buffer_load_dwordx4 v[92:95], v21, s[36:39], 0 offen sc1
L_p3n:
    s_waitcnt lgkmcnt(0)
    v_lshlrev_b32 v52, 16, v26
    v_and_b32 v53, 0xffff0000, v26
    v_lshlrev_b32 v54, 16, v27
    v_and_b32 v55, 0xffff0000, v27
    v_lshlrev_b32 v56, 16, v28
    v_and_b32 v57, 0xffff0000, v28
    v_lshlrev_b32 v58, 16, v29
    v_and_b32 v59, 0xffff0000, v29
    v_lshlrev_b32 v60, 16, v30
    v_and_b32 v61, 0xffff0000, v30
    v_lshlrev_b32 v62, 16, v31
    v_and_b32 v63, 0xffff0000, v31
    v_lshlrev_b32 v64, 16, v32
    v_and_b32 v65, 0xffff0000, v32
    v_lshlrev_b32 v66, 16, v33
    v_and_b32 v67, 0xffff0000, v33
    v_pk_add_f32 v[68:69], v[52:53], v[36:37] op_sel_hi:[1,0] neg_lo:[0,1] neg_hi:[0,1]
    v_pk_add_f32 v[70:71], v[54:55], v[38:39] op_sel_hi:[1,0] neg_lo:[0,1] neg_hi:[0,1]
    v_pk_add_f32 v[72:73], v[56:57], v[40:41] op_sel_hi:[1,0] neg_lo:[0,1] neg_hi:[0,1]
    v_pk_add_f32 v[74:75], v[58:59], v[42:43] op_sel_hi:[1,0] neg_lo:[0,1] neg_hi:[0,1]
    v_pk_add_f32 v[76:77], v[60:61], v[44:45] op_sel_hi:[1,0] neg_lo:[0,1] neg_hi:[0,1]
    v_pk_add_f32 v[78:79], v[62:63], v[46:47] op_sel_hi:[1,0] neg_lo:[0,1] neg_hi:[0,1]
    v_pk_add_f32 v[80:81], v[64:65], v[48:49] op_sel_hi:[1,0] neg_lo:[0,1] neg_hi:[0,1]
    v_pk_add_f32 v[82:83], v[66:67], v[50:51] op_sel_hi:[1,0] neg_lo:[0,1] neg_hi:[0,1]
    v_cvt_pk_bf16_f32 v26, v68, v69
    v_cvt_pk_bf16_f32 v27, v70, v71
    v_cvt_pk_bf16_f32 v28, v72, v73
    v_cvt_pk_bf16_f32 v29, v74, v75
    v_cvt_pk_bf16_f32 v30, v76, v77
    v_cvt_pk_bf16_f32 v31, v78, v79
    v_cvt_pk_bf16_f32 v32, v80, v81
    v_cvt_pk_bf16_f32 v33, v82, v83
    v_lshlrev_b32 v68, 16, v26
    v_and_b32 v69, 0xffff0000, v26
    v_lshlrev_b32 v70, 16, v27
    v_and_b32 v71, 0xffff0000, v27
    v_lshlrev_b32 v72, 16, v28
    v_and_b32 v73, 0xffff0000, v28
    v_lshlrev_b32 v74, 16, v29
    v_and_b32 v75, 0xffff0000, v29
    v_lshlrev_b32 v76, 16, v30
    v_and_b32 v77, 0xffff0000, v30
    v_lshlrev_b32 v78, 16, v31
    v_and_b32 v79, 0xffff0000, v31
    v_lshlrev_b32 v80, 16, v32
    v_and_b32 v81, 0xffff0000, v32
    v_lshlrev_b32 v82, 16, v33
    v_and_b32 v83, 0xffff0000, v33
    v_pk_mul_f32 v[68:69], v[68:69], v[36:37] op_sel:[0,1] op_sel_hi:[1,1]
    v_pk_mul_f32 v[70:71], v[70:71], v[38:39] op_sel:[0,1] op_sel_hi:[1,1]
    v_pk_mul_f32 v[72:73], v[72:73], v[40:41] op_sel:[0,1] op_sel_hi:[1,1]
    v_pk_mul_f32 v[74:75], v[74:75], v[42:43] op_sel:[0,1] op_sel_hi:[1,1]
    v_pk_mul_f32 v[76:77], v[76:77], v[44:45] op_sel:[0,1] op_sel_hi:[1,1]
    v_pk_mul_f32 v[78:79], v[78:79], v[46:47] op_sel:[0,1] op_sel_hi:[1,1]
    v_pk_mul_f32 v[80:81], v[80:81], v[48:49] op_sel:[0,1] op_sel_hi:[1,1]
    v_pk_mul_f32 v[82:83], v[82:83], v[50:51] op_sel:[0,1] op_sel_hi:[1,1]
    v_cvt_pk_bf16_f32 v26, v68, v69
    v_cvt_pk_bf16_f32 v27, v70, v71
    v_cvt_pk_bf16_f32 v28, v72, v73
    v_cvt_pk_bf16_f32 v29, v74, v75
    v_cvt_pk_bf16_f32 v30, v76, v77
    v_cvt_pk_bf16_f32 v31, v78, v79
    v_cvt_pk_bf16_f32 v32, v80, v81
    v_cvt_pk_bf16_f32 v33, v82, v83
    v_lshlrev_b32 v68, 16, v26
    v_and_b32 v69, 0xffff0000, v26
    v_lshlrev_b32 v70, 16, v27
    v_and_b32 v71, 0xffff0000, v27
    v_lshlrev_b32 v72, 16, v28
    v_and_b32 v73, 0xffff0000, v28
    v_lshlrev_b32 v74, 16, v29
    v_and_b32 v75, 0xffff0000, v29
    v_lshlrev_b32 v76, 16, v30
    v_and_b32 v77, 0xffff0000, v30
    v_lshlrev_b32 v78, 16, v31
    v_and_b32 v79, 0xffff0000, v31
    v_lshlrev_b32 v80, 16, v32
    v_and_b32 v81, 0xffff0000, v32
    v_lshlrev_b32 v82, 16, v33
    v_and_b32 v83, 0xffff0000, v33
    v_pk_add_f32 v[52:53], v[52:53], v[68:69]
    v_pk_add_f32 v[54:55], v[54:55], v[70:71]
    v_pk_add_f32 v[56:57], v[56:57], v[72:73]
    v_pk_add_f32 v[58:59], v[58:59], v[74:75]
    v_pk_add_f32 v[60:61], v[60:61], v[76:77]
    v_pk_add_f32 v[62:63], v[62:63], v[78:79]
    v_pk_add_f32 v[64:65], v[64:65], v[80:81]
    v_pk_add_f32 v[66:67], v[66:67], v[82:83]
    s_cmp_eq_u32 s47, 1
    s_cbranch_scc1 L_p3m
L_p3s:
    s_mov_b32 s68, 200000
    s_mov_b64 s[66:67], exec
L_poll_8:
    buffer_load_dwordx4 v[96:99], v17, s[36:39], 0 offen sc1
    s_waitcnt vmcnt(0)
    v_cmpx_eq_u32 vcc, s45, v99
    s_andn2_b64 s[66:67], s[66:67], exec
    s_cbranch_scc0 L_pollx_9
    s_mov_b64 exec, s[66:67]
    s_sub_u32 s68, s68, 1
    s_sleep 2
    s_cmp_lg_u32 s68, 0
    s_cbranch_scc1 L_poll_8
L_pollx_9:
    s_mov_b64 exec, -1
L_p3top:
    s_lshl_b32 s64, s43, 3
    s_movk_i32 s61, 5120
    s_mov_b32 s48, s26
    s_mov_b32 s49, s27
    s_mov_b32 s50, 2621440
    s_mov_b32 s51, 0x20000
    v_readfirstlane_b32 s62, v96
    v_readfirstlane_b32 s63, v97
    s_andn2_b32 s62, 0xffff, s62
    s_andn2_b32 s63, 0xffff, s63
    s_sub_u32 s62, s62, s64
    s_sub_u32 s63, s63, s64
    s_min_u32 s62, s62, 8
    s_min_u32 s63, s63, 8
    s_lshl_b32 s62, 1, s62
    s_lshl_b32 s63, 1, s63
    s_or_b32 s62, s62, s63
    s_mov_b32 s63, 0x7fff0000
    s_bitcmp1_b32 s62, 0
    s_cselect_b32 s4, s63, 0
    s_bitcmp1_b32 s62, 1
    s_cselect_b32 s5, s63, 0
    s_bitcmp1_b32 s62, 2
    s_cselect_b32 s6, s63, 0
    s_bitcmp1_b32 s62, 3
    s_cselect_b32 s7, s63, 0
    s_bitcmp1_b32 s62, 4
    s_cselect_b32 s8, s63, s61
    s_bitcmp1_b32 s62, 5
    s_cselect_b32 s9, s63, s61
    s_bitcmp1_b32 s62, 6
    s_cselect_b32 s10, s63, s61
    s_bitcmp1_b32 s62, 7
    s_cselect_b32 s11, s63, s61
    s_cmp_eq_u32 s47, 0
    s_cbranch_scc1 L_p3y
    s_cmp_eq_u32 s47, 1
    s_cbranch_scc1 L_p3f
    s_mov_b64 exec, 1
    s_mov_b32 s68, 200000
    s_mov_b64 s[66:67], exec
L_poll_10:
    buffer_load_dwordx4 v[84:87], v19, s[36:39], 0 offen sc1
    s_waitcnt vmcnt(0)
    v_cmpx_eq_u32 vcc, s45, v87
    s_andn2_b64 s[66:67], s[66:67], exec
    s_cbranch_scc0 L_pollx_11
    s_mov_b64 exec, s[66:67]
    s_sub_u32 s68, s68, 1
    s_sleep 8
    s_cmp_lg_u32 s68, 0
    s_cbranch_scc1 L_poll_10
L_pollx_11:
    s_mov_b64 exec, -1
L_p3y:
    s_mov_b32 s68, 200000
    s_mov_b64 s[66:67], exec
L_poll_12:
    buffer_load_dwordx4 v[84:87], v19, s[36:39], 0 offen sc1
    buffer_load_dwordx4 v[88:91], v20, s[36:39], 0 offen sc1
    buffer_load_dwordx4 v[92:95], v21, s[36:39], 0 offen sc1
L_pollm_14:
    s_waitcnt vmcnt(2)
    ds_write2_b32 v22, v84, v85 offset0:0 offset1:1
    ds_write_b32 v22, v86 offset:8
    s_waitcnt vmcnt(1)
    ds_write2_b32 v23, v88, v89 offset0:0 offset1:1
    ds_write_b32 v23, v90 offset:8
    s_waitcnt vmcnt(0)
    ds_write2_b32 v24, v92, v93 offset0:0 offset1:1
    ds_write_b32 v24, v94 offset:8
    v_cmpx_eq_u32 vcc, s45, v87
    v_cmpx_eq_u32 vcc, s45, v91
    v_cmpx_eq_u32 vcc, s45, v95
    s_andn2_b64 s[66:67], s[66:67], exec
    s_cbranch_scc0 L_pollx_13
    s_mov_b64 exec, s[66:67]
    s_sub_u32 s68, s68, 1
    s_sleep 1
    s_cmp_lg_u32 s68, 0
    s_cbranch_scc1 L_poll_12
L_pollx_13:
    s_mov_b64 exec, -1
L_p3f:
    ds_read_b128 v[100:103], v18
    ds_read_b128 v[104:107], v18 offset:16
    s_waitcnt lgkmcnt(0)
    v_lshlrev_b32 v108, 16, v100
    v_lshlrev_b32 v109, 16, v104
    v_and_b32 v110, 0xffff0000, v100
    v_and_b32 v111, 0xffff0000, v104
    v_pk_fma_f32 v[108:109], v[108:109], v[68:69], v[52:53]
    v_pk_fma_f32 v[110:111], v[110:111], v[70:71], v[54:55]
    v_cvt_pk_bf16_f32 v26, v108, v109
    v_cvt_pk_bf16_f32 v27, v110, v111
    buffer_store_dword v26, v16, s[48:51], s4 offen offset:0 sc1
    buffer_store_dword v27, v16, s[48:51], s5 offen offset:1280 sc1
    v_lshlrev_b32 v108, 16, v101
    v_lshlrev_b32 v109, 16, v105
    v_and_b32 v110, 0xffff0000, v101
    v_and_b32 v111, 0xffff0000, v105
    v_pk_fma_f32 v[108:109], v[108:109], v[72:73], v[56:57]
    v_pk_fma_f32 v[110:111], v[110:111], v[74:75], v[58:59]
    v_cvt_pk_bf16_f32 v28, v108, v109
    v_cvt_pk_bf16_f32 v29, v110, v111
    buffer_store_dword v28, v16, s[48:51], s6 offen offset:2560 sc1
    buffer_store_dword v29, v16, s[48:51], s7 offen offset:3840 sc1
    v_lshlrev_b32 v108, 16, v102
    v_lshlrev_b32 v109, 16, v106
    v_and_b32 v110, 0xffff0000, v102
    v_and_b32 v111, 0xffff0000, v106
    v_pk_fma_f32 v[108:109], v[108:109], v[76:77], v[60:61]
    v_pk_fma_f32 v[110:111], v[110:111], v[78:79], v[62:63]
    v_cvt_pk_bf16_f32 v30, v108, v109
    v_cvt_pk_bf16_f32 v31, v110, v111
    buffer_store_dword v30, v16, s[48:51], s8 offen offset:0 sc1
    buffer_store_dword v31, v16, s[48:51], s9 offen offset:1280 sc1
    v_lshlrev_b32 v108, 16, v103
    v_lshlrev_b32 v109, 16, v107
    v_and_b32 v110, 0xffff0000, v103
    v_and_b32 v111, 0xffff0000, v107
    v_pk_fma_f32 v[108:109], v[108:109], v[80:81], v[64:65]
    v_pk_fma_f32 v[110:111], v[110:111], v[82:83], v[66:67]
    v_cvt_pk_bf16_f32 v32, v108, v109
    v_cvt_pk_bf16_f32 v33, v110, v111
    buffer_store_dword v32, v16, s[48:51], s10 offen offset:2560 sc1
    buffer_store_dword v33, v16, s[48:51], s11 offen offset:3840 sc1
    s_branch L_done
L_p3m:
    s_mov_b32 s68, 200000
    s_mov_b64 s[66:67], exec
    s_branch L_pollm_17
L_poll_15:
    buffer_load_dwordx4 v[96:99], v17, s[36:39], 0 offen sc1
    buffer_load_dwordx4 v[84:87], v19, s[36:39], 0 offen sc1
    buffer_load_dwordx4 v[88:91], v20, s[36:39], 0 offen sc1
    buffer_load_dwordx4 v[92:95], v21, s[36:39], 0 offen sc1
L_pollm_17:
    s_waitcnt vmcnt(3)
    s_nop 0
    s_waitcnt vmcnt(2)
    ds_write2_b32 v22, v84, v85 offset0:0 offset1:1
    ds_write_b32 v22, v86 offset:8
    s_waitcnt vmcnt(1)
    ds_write2_b32 v23, v88, v89 offset0:0 offset1:1
    ds_write_b32 v23, v90 offset:8
    s_waitcnt vmcnt(0)
    ds_write2_b32 v24, v92, v93 offset0:0 offset1:1
    ds_write_b32 v24, v94 offset:8
    v_cmpx_eq_u32 vcc, s45, v87
    v_cmpx_eq_u32 vcc, s45, v91
    v_cmpx_eq_u32 vcc, s45, v95
    v_cmpx_eq_u32 vcc, s45, v99
    s_andn2_b64 s[66:67], s[66:67], exec
    s_cbranch_scc0 L_pollx_16
    s_mov_b64 exec, s[66:67]
    s_sub_u32 s68, s68, 1
    s_sleep 1
    s_cmp_lg_u32 s68, 0
    s_cbranch_scc1 L_poll_15
L_pollx_16:
    s_mov_b64 exec, -1
    s_branch L_p3top
L_helper:
    v_lshrrev_b32 v2, 3, v0
    v_and_b32 v4, 7, v0
    v_mul_u32_u24 v196, 104, v2
    v_mad_u32_u24 v196, v4, 12, v196
    v_add_u32 v196, 88320, v196
    v_add_u32 v198, 6656, v196
    v_mul_u32_u24 v197, 27392, v2
    v_lshl_add_u32 v197, v4, 4, v197
    s_lshl_b32 s56, s44, 7
    s_add_u32 s56, s56, 3506176
    s_add_u32 s57, s56, 1753088
    v_mov_b32 v203, s45
    v_mov_b32 v207, s45
    v_mov_b32 v3, 1
    s_waitcnt vmcnt(0)
    s_mov_b64 exec, 1
    ds_add_u32 v10, v3 offset:24
    s_mov_b64 exec, -1
L_lw_19:
    ds_read_b32 v2, v10 offset:24
    s_waitcnt lgkmcnt(0)
    v_cmp_gt_u32 vcc, 6, v2
    s_cbranch_vccnz L_lw_19
    s_mov_b32 s68, 200000
    s_mov_b64 s[66:67], exec
    s_mov_b32 s65, 0
    buffer_load_dwordx4 v[136:139], v191, s[36:39], s65 offen sc1
    s_mov_b32 s65, 876544
    buffer_load_dwordx4 v[140:143], v191, s[36:39], s65 offen sc1
    s_mov_b32 s65, 1753088
    buffer_load_dwordx4 v[144:147], v191, s[36:39], s65 offen sc1
    s_mov_b32 s65, 2629632
    buffer_load_dwordx4 v[148:151], v191, s[36:39], s65 offen sc1
L_lw_23:
    ds_read_b32 v2, v10 offset:20
    s_waitcnt lgkmcnt(0)
    v_cmp_gt_u32 vcc, 4, v2
    s_cbranch_vccnz L_lw_23
    ds_read_b64 v[40:41], v188 offset:0
    ds_read_b64 v[42:43], v188 offset:8
    ds_read_b64 v[44:45], v188 offset:512
    ds_read_b64 v[46:47], v188 offset:520
    ds_read_b64 v[48:49], v188 offset:1024
    ds_read_b64 v[50:51], v188 offset:1032
    ds_read_b64 v[52:53], v188 offset:1536
    ds_read_b64 v[54:55], v188 offset:1544
    ds_read_b64 v[56:57], v188 offset:2048
    ds_read_b64 v[58:59], v188 offset:2056
    ds_read_b64 v[60:61], v188 offset:2560
    ds_read_b64 v[62:63], v188 offset:2568
    ds_read_b64 v[64:65], v188 offset:3072
    ds_read_b64 v[66:67], v188 offset:3080
    ds_read_b64 v[68:69], v188 offset:3584
    ds_read_b64 v[70:71], v188 offset:3592
    s_branch L_pollm_22
L_poll_20:
    s_mov_b32 s65, 0
    buffer_load_dwordx4 v[136:139], v191, s[36:39], s65 offen sc1
    s_mov_b32 s65, 876544
    buffer_load_dwordx4 v[140:143], v191, s[36:39], s65 offen sc1
    s_mov_b32 s65, 1753088
    buffer_load_dwordx4 v[144:147], v191, s[36:39], s65 offen sc1
    s_mov_b32 s65, 2629632
    buffer_load_dwordx4 v[148:151], v191, s[36:39], s65 offen sc1
L_pollm_22:
    s_waitcnt vmcnt(3)
    ds_write_b32 v194, v136 offset:0
    ds_write_b32 v194, v137 offset:4
    ds_write_b32 v194, v138 offset:8
    s_waitcnt vmcnt(2)
    ds_write_b32 v194, v140 offset:3072
    ds_write_b32 v194, v141 offset:3076
    ds_write_b32 v194, v142 offset:3080
    s_waitcnt vmcnt(1)
    ds_write_b32 v194, v144 offset:6144
    ds_write_b32 v194, v145 offset:6148
    ds_write_b32 v194, v146 offset:6152
    s_waitcnt vmcnt(0)
    ds_write_b32 v194, v148 offset:9216
    ds_write_b32 v194, v149 offset:9220
    ds_write_b32 v194, v150 offset:9224
    v_cmpx_eq_u32 vcc, s45, v139
    v_cmpx_eq_u32 vcc, s45, v143
    v_cmpx_eq_u32 vcc, s45, v147
    v_cmpx_eq_u32 vcc, s45, v151
    s_andn2_b64 s[66:67], s[66:67], exec
    s_cbranch_scc0 L_pollx_21
    s_mov_b64 exec, s[66:67]
    s_sub_u32 s68, s68, 1
    s_sleep 1
    s_cmp_lg_u32 s68, 0
    s_cbranch_scc1 L_poll_20
L_pollx_21:
    s_mov_b64 exec, -1
    s_waitcnt lgkmcnt(0)
    s_barrier
    s_mov_b32 s64, 0
L_hstart:
    ds_read_b128 v[104:107], v189 offset:192
    ds_read_b128 v[108:111], v189 offset:1728
    ds_read_b128 v[112:115], v189 offset:3264
    ds_read_b128 v[116:119], v189 offset:4800
    ds_read_b128 v[120:123], v189 offset:6336
    ds_read_b128 v[124:127], v189 offset:7872
    ds_read_b128 v[128:131], v189 offset:9408
    ds_read_b128 v[132:135], v189 offset:10944
    s_waitcnt lgkmcnt(0)
    s_branch L_h1
L_hloop:
    s_nop 4
    ds_write_b128 v192, v[32:35] offset:6144
    ds_write_b128 v192, v[36:39] offset:7168
    ds_write_b32 v193, v193
    v_add_u32 v192, 8192, v192
    v_add_u32 v193, 4, v193
    s_waitcnt lgkmcnt(3)
L_h1:
    v_mfma_f32_16x16x32_bf16 v[16:19], v[44:47], v[108:111], 0
    ds_read_b64 v[72:73], v188 offset:64
    v_mfma_f32_16x16x32_bf16 v[16:19], v[40:43], v[112:115], v[16:19]
    ds_read_b64 v[74:75], v188 offset:72
    v_mfma_f32_16x16x32_bf16 v[16:19], v[48:51], v[104:107], v[16:19]
    ds_read_b128 v[136:139], v189 offset:0
    v_mfma_f32_16x16x32_bf16 v[20:23], v[44:47], v[112:115], 0
    ds_read_b64 v[76:77], v188 offset:576
    v_mfma_f32_16x16x32_bf16 v[20:23], v[48:51], v[108:111], v[20:23]
    ds_read_b64 v[78:79], v188 offset:584
    v_mfma_f32_16x16x32_bf16 v[24:27], v[48:51], v[112:115], 0
    ds_read_b128 v[140:143], v189 offset:1536
    v_mfma_f32_16x16x32_bf16 v[20:23], v[40:43], v[116:119], v[20:23]
    ds_read_b64 v[80:81], v188 offset:1088
    v_mfma_f32_16x16x32_bf16 v[20:23], v[52:55], v[104:107], v[20:23]
    ds_read_b64 v[82:83], v188 offset:1096
    v_mfma_f32_16x16x32_bf16 v[24:27], v[44:47], v[116:119], v[24:27]
    ds_read_b128 v[144:147], v189 offset:3072
    v_mfma_f32_16x16x32_bf16 v[24:27], v[52:55], v[108:111], v[24:27]
    ds_read_b64 v[84:85], v188 offset:1600
    v_mfma_f32_16x16x32_bf16 v[28:31], v[48:51], v[116:119], 0
    ds_read_b64 v[86:87], v188 offset:1608
    v_mfma_f32_16x16x32_bf16 v[28:31], v[52:55], v[112:115], v[28:31]
    ds_read_b128 v[148:151], v189 offset:4608
    v_mfma_f32_16x16x32_bf16 v[32:35], v[52:55], v[116:119], 0
    ds_read_b64 v[88:89], v188 offset:2112
    v_mfma_f32_16x16x32_bf16 v[24:27], v[40:43], v[120:123], v[24:27]
    ds_read_b64 v[90:91], v188 offset:2120
    v_mfma_f32_16x16x32_bf16 v[24:27], v[56:59], v[104:107], v[24:27]
    ds_read_b128 v[152:155], v189 offset:6144
    v_mfma_f32_16x16x32_bf16 v[28:31], v[44:47], v[120:123], v[28:31]
    ds_read_b64 v[92:93], v188 offset:2624
    v_mfma_f32_16x16x32_bf16 v[28:31], v[56:59], v[108:111], v[28:31]
    ds_read_b64 v[94:95], v188 offset:2632
    v_mfma_f32_16x16x32_bf16 v[32:35], v[48:51], v[120:123], v[32:35]
    ds_read_b128 v[156:159], v189 offset:7680
    v_mfma_f32_16x16x32_bf16 v[32:35], v[56:59], v[112:115], v[32:35]
    ds_read_b64 v[96:97], v188 offset:3136
    v_mfma_f32_16x16x32_bf16 v[36:39], v[52:55], v[120:123], 0
    ds_read_b64 v[98:99], v188 offset:3144
    v_mfma_f32_16x16x32_bf16 v[36:39], v[56:59], v[116:119], v[36:39]
    ds_read_b128 v[160:163], v189 offset:9216
    v_mfma_f32_16x16x32_bf16 v[28:31], v[40:43], v[124:127], v[28:31]
    ds_read_b64 v[100:101], v188 offset:3648
    v_mfma_f32_16x16x32_bf16 v[28:31], v[60:63], v[104:107], v[28:31]
    ds_read_b64 v[102:103], v188 offset:3656
    v_mfma_f32_16x16x32_bf16 v[32:35], v[44:47], v[124:127], v[32:35]
    ds_read_b128 v[164:167], v189 offset:10752
    v_mfma_f32_16x16x32_bf16 v[32:35], v[60:63], v[108:111], v[32:35]
    v_mfma_f32_16x16x32_bf16 v[36:39], v[48:51], v[124:127], v[36:39]
    v_mfma_f32_16x16x32_bf16 v[36:39], v[60:63], v[112:115], v[36:39]
    v_mfma_f32_16x16x32_bf16 v[32:35], v[40:43], v[128:131], v[32:35]
    v_mfma_f32_16x16x32_bf16 v[32:35], v[64:67], v[104:107], v[32:35]
    v_mfma_f32_16x16x32_bf16 v[36:39], v[44:47], v[128:131], v[36:39]
    v_mfma_f32_16x16x32_bf16 v[36:39], v[64:67], v[108:111], v[36:39]
    v_add_u32 v188, 16640, v188
    v_add_u32 v189, 16, v189
    v_mfma_f32_16x16x32_bf16 v[36:39], v[40:43], v[132:135], v[36:39]
    v_mfma_f32_16x16x32_bf16 v[36:39], v[68:71], v[104:107], v[36:39]
    s_waitcnt lgkmcnt(0)
    v_mfma_f32_16x16x32_bf16 v[16:19], v[76:79], v[140:143], v[16:19]
    ds_read_b64 v[40:41], v188 offset:0
    v_mfma_f32_16x16x32_bf16 v[16:19], v[72:75], v[144:147], v[16:19]
    ds_read_b64 v[42:43], v188 offset:8
    v_mfma_f32_16x16x32_bf16 v[16:19], v[80:83], v[136:139], v[16:19]
    ds_read_b128 v[104:107], v189 offset:192
    v_mfma_f32_16x16x32_bf16 v[20:23], v[76:79], v[144:147], v[20:23]
    ds_read_b64 v[44:45], v188 offset:512
    v_mfma_f32_16x16x32_bf16 v[20:23], v[80:83], v[140:143], v[20:23]
    ds_read_b64 v[46:47], v188 offset:520
    v_mfma_f32_16x16x32_bf16 v[24:27], v[80:83], v[144:147], v[24:27]
    ds_read_b128 v[108:111], v189 offset:1728
    v_mfma_f32_16x16x32_bf16 v[20:23], v[72:75], v[148:151], v[20:23]
    ds_read_b64 v[48:49], v188 offset:1024
    v_mfma_f32_16x16x32_bf16 v[20:23], v[84:87], v[136:139], v[20:23]
    ds_read_b64 v[50:51], v188 offset:1032
    v_mfma_f32_16x16x32_bf16 v[24:27], v[76:79], v[148:151], v[24:27]
    ds_read_b128 v[112:115], v189 offset:3264
    v_mfma_f32_16x16x32_bf16 v[24:27], v[84:87], v[140:143], v[24:27]
    ds_read_b64 v[52:53], v188 offset:1536
    v_mfma_f32_16x16x32_bf16 v[28:31], v[80:83], v[148:151], v[28:31]
    ds_read_b64 v[54:55], v188 offset:1544
    v_mfma_f32_16x16x32_bf16 v[28:31], v[84:87], v[144:147], v[28:31]
    ds_read_b128 v[116:119], v189 offset:4800
    v_mfma_f32_16x16x32_bf16 v[32:35], v[84:87], v[148:151], v[32:35]
    ds_read_b64 v[56:57], v188 offset:2048
    v_mfma_f32_16x16x32_bf16 v[24:27], v[72:75], v[152:155], v[24:27]
    ds_read_b64 v[58:59], v188 offset:2056
    v_mfma_f32_16x16x32_bf16 v[24:27], v[88:91], v[136:139], v[24:27]
    ds_read_b128 v[120:123], v189 offset:6336
    v_mfma_f32_16x16x32_bf16 v[28:31], v[76:79], v[152:155], v[28:31]
    ds_read_b64 v[60:61], v188 offset:2560
    v_mfma_f32_16x16x32_bf16 v[28:31], v[88:91], v[140:143], v[28:31]
    ds_read_b64 v[62:63], v188 offset:2568
    v_mfma_f32_16x16x32_bf16 v[32:35], v[80:83], v[152:155], v[32:35]
    ds_read_b128 v[124:127], v189 offset:7872
    v_mfma_f32_16x16x32_bf16 v[32:35], v[88:91], v[144:147], v[32:35]
    ds_read_b64 v[64:65], v188 offset:3072
    v_mfma_f32_16x16x32_bf16 v[36:39], v[84:87], v[152:155], v[36:39]
    ds_read_b64 v[66:67], v188 offset:3080
    v_mfma_f32_16x16x32_bf16 v[36:39], v[88:91], v[148:151], v[36:39]
    ds_read_b128 v[128:131], v189 offset:9408
    v_mfma_f32_16x16x32_bf16 v[28:31], v[72:75], v[156:159], v[28:31]
    ds_read_b64 v[68:69], v188 offset:3584
    v_mfma_f32_16x16x32_bf16 v[28:31], v[92:95], v[136:139], v[28:31]
    ds_read_b64 v[70:71], v188 offset:3592
    v_mfma_f32_16x16x32_bf16 v[32:35], v[76:79], v[156:159], v[32:35]
    ds_read_b128 v[132:135], v189 offset:10944
    v_mfma_f32_16x16x32_bf16 v[32:35], v[92:95], v[140:143], v[32:35]
    ds_write_b128 v192, v[16:19] offset:2048
    v_mfma_f32_16x16x32_bf16 v[36:39], v[80:83], v[156:159], v[36:39]
    v_mfma_f32_16x16x32_bf16 v[36:39], v[92:95], v[144:147], v[36:39]
    ds_write_b128 v192, v[20:23] offset:3072
    v_mfma_f32_16x16x32_bf16 v[32:35], v[72:75], v[160:163], v[32:35]
    v_mfma_f32_16x16x32_bf16 v[32:35], v[96:99], v[136:139], v[32:35]
    ds_write_b128 v192, v[24:27] offset:4096
    v_mfma_f32_16x16x32_bf16 v[36:39], v[76:79], v[160:163], v[36:39]
    v_mfma_f32_16x16x32_bf16 v[36:39], v[96:99], v[140:143], v[36:39]
    v_mfma_f32_16x16x32_bf16 v[36:39], v[72:75], v[164:167], v[36:39]
    ds_write_b128 v192, v[28:31] offset:5120
    v_mfma_f32_16x16x32_bf16 v[36:39], v[100:103], v[136:139], v[36:39]
    s_add_u32 s64, s64, 1
    s_cmp_lt_u32 s64, 3
    s_cbranch_scc1 L_hloop
    s_nop 4
    ds_write_b128 v192, v[32:35] offset:6144
    ds_write_b128 v192, v[36:39] offset:7168
    ds_write_b32 v193, v193
    s_branch L_b4join
L_ln:
    s_mul_i32 s44, s41, 27
    s_add_u32 s44, s44, s42
    s_mul_i32 s69, s44, 3
    s_cmp_ge_u32 s44, 214
    s_cselect_b32 s47, 2, 0
    s_lshl_b32 s63, s41, 2
    s_add_u32 s63, s63, s42
    s_sub_u32 s63, s63, 27
    s_cmp_ge_u32 s63, 27
    s_cselect_b32 s64, 2, 1
    s_cmp_eq_u32 s42, 31
    s_cselect_b32 s64, 2, s64
    s_cmp_ge_u32 s42, 27
    s_cselect_b32 s47, s64, s47
    s_cselect_b32 s44, s63, s44
    s_mov_b32 s36, s30
    s_mov_b32 s37, s31
    s_mov_b32 s38, 7339136
    s_mov_b32 s39, 0x20000
    s_cmp_lg_u32 s47, 0
    s_cbranch_scc1 L_nh
L_nh:
    s_waitcnt lgkmcnt(0)
    s_mul_i32 s45, s45, 0x9e3779b1
    s_add_u32 s45, s45, 0x7f4a7c15
    s_cmp_eq_u32 s45, 0
    s_cselect_b32 s45, 0x7f4a7c15, s45
    v_mov_b32 v2, 101776
    v_mov_b32 v3, s45
    ds_write_b32 v2, v3 offset:12
    s_cmp_lg_u32 s47, 0
    s_cbranch_scc1 L_nh2
    s_waitcnt vmcnt(0)
    s_waitcnt vmcnt(12)
    s_branch L_qok
L_nh2:
    s_cmp_lg_u32 s47, 1
    s_cbranch_scc1 L_nh3
    s_lshl_b32 s60, s40, 7
    s_lshl_b32 s61, s40, 5
    s_add_u32 s61, s61, 384
    s_cmp_lt_u32 s40, 4
    s_cselect_b32 s60, s60, s61
    v_and_b32 v244, 15, v1
    v_lshrrev_b32 v245, 4, v1
    v_lshl_add_u32 v2, v245, 3, s60
    v_mul_u32_u24 v2, 3456, v2
    v_and_b32 v3, 7, v1
    v_lshl_add_u32 v2, v3, 4, v2
    s_lshl_b32 s62, s44, 7
    v_add_u32 v2, s62, v2
    v_and_b32 v3, 8, v1
    v_cmp_ne_u32 vcc, 0, v3
    v_mov_b32 v240, s20
    v_mov_b32 v241, s21
    v_mov_b32 v3, s22
    v_mov_b32 v4, s23
    v_cndmask_b32 v240, v240, v3, vcc
    v_cndmask_b32 v241, v241, v4, vcc
    v_add_co_u32 v240, vcc, v240, v2
    s_nop 1
    v_addc_co_u32 v241, vcc, 0, v241, vcc
    s_mov_b32 s62, 6912
    s_mov_b32 s63, 0
    s_mov_b32 s64, 89856
    s_mov_b32 s65, 0
    global_load_dwordx4 v[200:203], v[240:241], off
    global_load_dwordx4 v[204:207], v[240:241], off offset:3456
    v_lshl_add_u64 v[240:241], v[240:241], 0, s[62:63]
    global_load_dwordx4 v[208:211], v[240:241], off
    global_load_dwordx4 v[212:215], v[240:241], off offset:3456
    v_lshl_add_u64 v[240:241], v[240:241], 0, s[62:63]
    global_load_dwordx4 v[216:219], v[240:241], off
    global_load_dwordx4 v[220:223], v[240:241], off offset:3456
    v_lshl_add_u64 v[240:241], v[240:241], 0, s[62:63]
    global_load_dwordx4 v[224:227], v[240:241], off
    global_load_dwordx4 v[228:231], v[240:241], off offset:3456
    v_lshl_add_u64 v[240:241], v[240:241], 0, s[64:65]
    s_waitcnt vmcnt(8)
    s_branch L_qok
L_nh3:
    s_waitcnt vmcnt(0)
L_qok:
    s_mov_b32 s63, 0x3f803f80
    v_dot2_f32_bf16 v57, v40, s63, 0
    v_dot2_f32_bf16 v45, v8, s63, 0
    v_dot2_f32_bf16 v46, v16, s63, 0
    v_dot2_f32_bf16 v47, v24, s63, 0
    v_dot2_f32_bf16 v48, v32, s63, 0
    v_dot2_f32_bf16 v49, v8, v8, 0
    v_dot2_f32_bf16 v50, v16, v16, 0
    v_dot2_f32_bf16 v51, v24, v24, 0
    v_dot2_f32_bf16 v52, v32, v32, 0
    v_dot2_f32_bf16 v53, v8, v40, 0
    v_dot2_f32_bf16 v54, v16, v40, 0
    v_dot2_f32_bf16 v55, v24, v40, 0
    v_dot2_f32_bf16 v56, v32, v40, 0
    v_dot2_f32_bf16 v57, v41, s63, v57
    v_dot2_f32_bf16 v45, v9, s63, v45
    v_dot2_f32_bf16 v46, v17, s63, v46
    v_dot2_f32_bf16 v47, v25, s63, v47
    v_dot2_f32_bf16 v48, v33, s63, v48
    v_dot2_f32_bf16 v49, v9, v9, v49
    v_dot2_f32_bf16 v50, v17, v17, v50
    v_dot2_f32_bf16 v51, v25, v25, v51
    v_dot2_f32_bf16 v52, v33, v33, v52
    v_dot2_f32_bf16 v53, v9, v41, v53
    v_dot2_f32_bf16 v54, v17, v41, v54
    v_dot2_f32_bf16 v55, v25, v41, v55
    v_dot2_f32_bf16 v56, v33, v41, v56
    v_dot2_f32_bf16 v57, v42, s63, v57
    v_dot2_f32_bf16 v45, v10, s63, v45
    v_dot2_f32_bf16 v46, v18, s63, v46
    v_dot2_f32_bf16 v47, v26, s63, v47
    v_dot2_f32_bf16 v48, v34, s63, v48
    v_dot2_f32_bf16 v49, v10, v10, v49
    v_dot2_f32_bf16 v50, v18, v18, v50
    v_dot2_f32_bf16 v51, v26, v26, v51
    v_dot2_f32_bf16 v52, v34, v34, v52
    v_dot2_f32_bf16 v53, v10, v42, v53
    v_dot2_f32_bf16 v54, v18, v42, v54
    v_dot2_f32_bf16 v55, v26, v42, v55
    v_dot2_f32_bf16 v56, v34, v42, v56
    v_dot2_f32_bf16 v57, v43, s63, v57
    v_dot2_f32_bf16 v45, v11, s63, v45
    v_dot2_f32_bf16 v46, v19, s63, v46
    v_dot2_f32_bf16 v47, v27, s63, v47
    v_dot2_f32_bf16 v48, v35, s63, v48
    v_dot2_f32_bf16 v49, v11, v11, v49
    v_dot2_f32_bf16 v50, v19, v19, v50
    v_dot2_f32_bf16 v51, v27, v27, v51
    v_dot2_f32_bf16 v52, v35, v35, v52
    v_dot2_f32_bf16 v53, v11, v43, v53
    v_dot2_f32_bf16 v54, v19, v43, v54
    v_dot2_f32_bf16 v55, v27, v43, v55
    v_dot2_f32_bf16 v56, v35, v43, v56
    v_dot2_f32_bf16 v57, v44, s63, v57
    v_dot2_f32_bf16 v45, v12, s63, v45
    v_dot2_f32_bf16 v46, v20, s63, v46
    v_dot2_f32_bf16 v47, v28, s63, v47
    v_dot2_f32_bf16 v48, v36, s63, v48
    v_dot2_f32_bf16 v49, v12, v12, v49
    v_dot2_f32_bf16 v50, v20, v20, v50
    v_dot2_f32_bf16 v51, v28, v28, v51
    v_dot2_f32_bf16 v52, v36, v36, v52
    v_dot2_f32_bf16 v53, v12, v44, v53
    v_dot2_f32_bf16 v54, v20, v44, v54
    v_dot2_f32_bf16 v55, v28, v44, v55
    v_dot2_f32_bf16 v56, v36, v44, v56
    v_mov_b32 v58, v57
    v_mov_b32 v59, v57
    v_mov_b32 v60, v57
    v_mov_b32 v2, 0x3acccccd
    v_permlane32_swap_b32 v45, v47
    v_permlane32_swap_b32 v46, v48
    v_permlane32_swap_b32 v49, v51
    v_permlane32_swap_b32 v50, v52
    v_permlane32_swap_b32 v53, v55
    v_permlane32_swap_b32 v54, v56
    v_permlane32_swap_b32 v57, v59
    v_permlane32_swap_b32 v58, v60
    v_add_f32 v45, v45, v47
    v_add_f32 v46, v46, v48
    v_add_f32 v49, v49, v51
    v_add_f32 v50, v50, v52
    v_add_f32 v53, v53, v55
    v_add_f32 v54, v54, v56
    v_add_f32 v57, v57, v59
    v_add_f32 v58, v58, v60
    v_permlane16_swap_b32 v45, v46
    v_permlane16_swap_b32 v49, v50
    v_permlane16_swap_b32 v53, v54
    v_permlane16_swap_b32 v57, v58
    v_add_f32 v45, v45, v46
    v_add_f32 v49, v49, v50
    v_add_f32 v53, v53, v54
    v_add_f32 v57, v57, v58
    v_add_f32_dpp v45, v45, v45 row_ror:8 row_mask:0xf bank_mask:0xf
    v_add_f32_dpp v49, v49, v49 row_ror:8 row_mask:0xf bank_mask:0xf
    v_add_f32_dpp v53, v53, v53 row_ror:8 row_mask:0xf bank_mask:0xf
    v_add_f32_dpp v57, v57, v57 row_ror:8 row_mask:0xf bank_mask:0xf
    v_add_f32_dpp v45, v45, v45 row_ror:4 row_mask:0xf bank_mask:0xf
    v_add_f32_dpp v49, v49, v49 row_ror:4 row_mask:0xf bank_mask:0xf
    v_add_f32_dpp v53, v53, v53 row_ror:4 row_mask:0xf bank_mask:0xf
    v_add_f32_dpp v57, v57, v57 row_ror:4 row_mask:0xf bank_mask:0xf
    v_add_f32_dpp v45, v45, v45 row_ror:2 row_mask:0xf bank_mask:0xf
    v_add_f32_dpp v49, v49, v49 row_ror:2 row_mask:0xf bank_mask:0xf
    v_add_f32_dpp v53, v53, v53 row_ror:2 row_mask:0xf bank_mask:0xf
    v_add_f32_dpp v57, v57, v57 row_ror:2 row_mask:0xf bank_mask:0xf
    v_add_f32_dpp v45, v45, v45 row_ror:1 row_mask:0xf bank_mask:0xf
    v_add_f32_dpp v49, v49, v49 row_ror:1 row_mask:0xf bank_mask:0xf
    v_add_f32_dpp v53, v53, v53 row_ror:1 row_mask:0xf bank_mask:0xf
    v_add_f32_dpp v57, v57, v57 row_ror:1 row_mask:0xf bank_mask:0xf
    v_mul_f32 v62, v45, v2
    v_mul_f32 v64, v49, v2
    v_fma_f32 v63, -v62, v62, v64
    v_mul_f32 v65, 0x44800000, v63
    v_cmp_lt_f32 vcc, v65, v64
    s_cbranch_vccnz L_slow
L_vok:
    v_cvt_pk_bf16_f32 v65, v62, v63
    v_lshlrev_b32 v62, 16, v65
    v_and_b32 v63, 0xffff0000, v65
    v_add_f32 v63, 0x3727c5ac, v63
    v_cvt_pk_bf16_f32 v65, v63, v63
    v_lshlrev_b32 v63, 16, v65
    v_sqrt_f32 v63, v63
    v_fma_f32 v67, -v62, v57, v53
    v_cvt_pk_bf16_f32 v66, v62, v63
    v_and_b32 v63, 0xffff0000, v66
    v_rcp_f32 v63, v63
    v_lshrrev_b32 v4, 4, v1
    v_add_u32 v4, s46, v4
    v_mul_f32 v67, v67, v63
    s_lshl_b32 s62, s43, 3
    s_sub_u32 s62, 0xffff, s62
    v_cvt_pk_bf16_f32 v65, v67, v67
    v_ashrrev_i32 v67, 31, v65
    v_or_b32 v67, 0x80000000, v67
    v_xor_b32 v65, v65, v67
    v_sub_u32 v67, s62, v4
    s_mov_b32 s62, 0xffff0000
    v_and_or_b32 v65, v65, s62, v67
    v_lshlrev_b32 v2, 2, v4
    v_lshlrev_b32 v3, 3, v4
    v_add_u32 v2, 101696, v2
    v_add_u32 v3, 101632, v3
    v_mov_b32 v4, 101776
    v_mov_b32 v84, 1
    s_mov_b32 exec_lo, 0x00010001
    s_mov_b32 exec_hi, 0x00010001
    ds_write2_b32 v2, v65, v66 offset0:0 offset1:8
    ds_write_b64 v3, v[62:63]
    s_mov_b64 exec, 1
    ds_add_rtn_u32 v84, v4, v84 offset:16
    s_mov_b64 exec, -1
    v_and_b32 v2, 7, v1
    v_lshlrev_b32 v2, 2, v2
    v_add_u32 v2, 101696, v2
    v_mul_u32_u24 v3, 12, v1
    v_add_u32 v3, 101716, v3
    s_mov_b32 s62, 0x7ffffff0
    s_waitcnt lgkmcnt(0)
    v_readfirstlane_b32 s64, v84
    s_cmp_lg_u32 s64, 1
    s_cbranch_scc1 L_nokey
    ds_read_b32 v45, v2
    s_mov_b64 exec, 0xf
    ds_read2_b32 v[80:81], v3 offset0:0 offset1:1
    ds_read_b32 v82, v3 offset:8
    s_mov_b64 exec, -1
    v_mov_b32 v46, 0
    v_mov_b32 v83, s45
    s_lshl_b32 s62, s43, 6
    s_add_u32 s62, s62, 7012352
    s_waitcnt lgkmcnt(0)
    v_mov_b32 v47, 0
    v_mov_b32 v48, 0
    s_nop 0
    v_mov_b32_dpp v47, v45 row_shr:1 row_mask:0xf bank_mask:0xf
    v_mov_b32_dpp v48, v46 row_shr:1 row_mask:0xf bank_mask:0xf
    v_min_u32 v2, v45, v47
    v_max_u32 v45, v45, v47
    v_max3_u32 v46, v46, v48, v2
    v_mov_b32 v47, 0
    v_mov_b32 v48, 0
    s_nop 0
    v_mov_b32_dpp v47, v45 row_shr:2 row_mask:0xf bank_mask:0xf
    v_mov_b32_dpp v48, v46 row_shr:2 row_mask:0xf bank_mask:0xf
    v_min_u32 v2, v45, v47
    v_max_u32 v45, v45, v47
    v_max3_u32 v46, v46, v48, v2
    v_mov_b32 v47, 0
    v_mov_b32 v48, 0
    s_nop 0
    v_mov_b32_dpp v47, v45 row_shr:4 row_mask:0xf bank_mask:0xf
    v_mov_b32_dpp v48, v46 row_shr:4 row_mask:0xf bank_mask:0xf
    v_min_u32 v2, v45, v47
    v_max_u32 v45, v45, v47
    v_max3_u32 v46, v46, v48, v2
    s_nop 0
    v_readlane_b32 s64, v45, 7
    v_readlane_b32 s65, v46, 7
    s_nop 1
    v_writelane_b32 v80, s64, 0
    v_writelane_b32 v81, s65, 0
L_nokey:
    s_mov_b64 exec, 0xf
    buffer_store_dwordx4 v[80:83], v5, s[36:39], s62 offen sc1
    s_mov_b64 exec, -1
    s_mul_i32 s62, s46, 1280
    s_add_u32 s62, s62, 101808
    v_add_u32 v2, s62, v5
    v_add_u32 v3, s62, v6
    v_mov_b32 v84, 1
    ds_write_b128 v2, v[8:11] offset:0
    ds_write_b32 v3, v12 offset:1024
    ds_write_b128 v2, v[16:19] offset:1280
    ds_write_b32 v3, v20 offset:2304
    ds_write_b128 v2, v[24:27] offset:2560
    ds_write_b32 v3, v28 offset:3584
    ds_write_b128 v2, v[32:35] offset:3840
    ds_write_b32 v3, v36 offset:4864
    s_cmp_lg_u32 s47, 0
    s_cbranch_scc1 L_nonconv
L_drmback:
    s_mov_b64 exec, -1
L_xwait:
    v_mov_b64 v[152:153], 0
    v_mov_b64 v[154:155], 0
    ds_write_b128 v5, v[152:155] offset:49920
    v_lshlrev_b32 v2, 3, v1
    ds_write_b64 v2, v[152:153] offset:50944
    v_subrev_u32 v176, 256, v0
    v_lshlrev_b32 v176, 4, v176
    v_lshrrev_b32 v177, 4, v1
    v_min_u32 v177, 2, v177
    v_mul_u32_u24 v177, 16640, v177
    v_lshrrev_b32 v180, 2, v1
    v_and_b32 v181, 3, v180
    v_lshlrev_b32 v181, 4, v181
    v_sub_u32 v181, 64, v181
    v_mul_u32_u24 v180, 4160, v180
    v_and_b32 v2, 3, v1
    v_lshl_add_u32 v180, v2, 3, v180
    v_mov_b32 v3, 101776
L_lw_25:
    ds_read_b32 v2, v3 offset:24
    s_waitcnt lgkmcnt(0)
    v_cmp_gt_u32 vcc, 6, v2
    s_cbranch_vccnz L_lw_25
    ds_read_b128 v[116:119], v176 offset:32
    ds_read_b64 v[120:121], v176 offset:48
    ds_read_b128 v[122:125], v176 offset:16672
    ds_read_b64 v[126:127], v176 offset:16688
    ds_read_b128 v[128:131], v176 offset:33312
    ds_read_b64 v[132:133], v176 offset:33328
    ds_read_b64 v[178:179], v177 offset:32
    s_waitcnt lgkmcnt(5)
    v_alignbit_b32 v152, v117, v116, 16
    v_alignbit_b32 v156, v118, v117, 16
    v_alignbit_b32 v153, v118, v117, 16
    v_alignbit_b32 v157, v119, v118, 16
    v_alignbit_b32 v154, v119, v118, 16
    v_alignbit_b32 v158, v120, v119, 16
    v_alignbit_b32 v155, v120, v119, 16
    v_alignbit_b32 v159, v121, v120, 16
    ds_write_b128 v176, v[152:155] offset:4192
    ds_write_b128 v176, v[156:159] offset:12512
    s_waitcnt lgkmcnt(5)
    v_alignbit_b32 v160, v123, v122, 16
    v_alignbit_b32 v164, v124, v123, 16
    v_alignbit_b32 v161, v124, v123, 16
    v_alignbit_b32 v165, v125, v124, 16
    v_alignbit_b32 v162, v125, v124, 16
    v_alignbit_b32 v166, v126, v125, 16
    v_alignbit_b32 v163, v126, v125, 16
    v_alignbit_b32 v167, v127, v126, 16
    ds_write_b128 v176, v[160:163] offset:20832
    ds_write_b128 v176, v[164:167] offset:29152
    s_waitcnt lgkmcnt(5)
    v_alignbit_b32 v168, v129, v128, 16
    v_alignbit_b32 v172, v130, v129, 16
    v_alignbit_b32 v169, v130, v129, 16
    v_alignbit_b32 v173, v131, v130, 16
    v_alignbit_b32 v170, v131, v130, 16
    v_alignbit_b32 v174, v132, v131, 16
    v_alignbit_b32 v171, v132, v131, 16
    v_alignbit_b32 v175, v133, v132, 16
    ds_write_b128 v176, v[168:171] offset:37472
    ds_write_b128 v176, v[172:175] offset:45792
    s_waitcnt lgkmcnt(6)
    v_lshlrev_b64 v[178:179], v181, v[178:179]
    s_mov_b32 exec_lo, 0x777f777f
    s_mov_b32 exec_hi, 0x777f
    v_mov_b64 v[178:179], 0
    s_mov_b32 exec_lo, -1
    s_mov_b32 exec_hi, 0xffff
    ds_write_b64 v180, v[178:179]
    s_mov_b64 exec, 1
    v_mov_b32 v2, 1
    ds_add_u32 v3, v2 offset:20
    s_mov_b64 exec, -1
    s_waitcnt lgkmcnt(0)
L_cwait:
    v_lshrrev_b32 v2, 3, v0
    v_and_b32 v4, 7, v0
    v_mul_u32_u24 v196, 104, v2
    v_mad_u32_u24 v196, v4, 12, v196
    v_add_u32 v196, 88320, v196
    v_add_u32 v198, 6656, v196
    v_mul_u32_u24 v197, 27392, v2
    v_lshl_add_u32 v197, v4, 4, v197
    s_lshl_b32 s56, s44, 7
    s_add_u32 s56, s56, 3506176
    s_add_u32 s57, s56, 1753088
    v_mov_b32 v203, s45
    v_mov_b32 v207, s45
    s_cmp_eq_u32 s40, 6
    s_cselect_b64 s[52:53], s[20:21], s[22:23]
    s_movk_i32 s62, 3456
    s_movk_i32 s63, 128
    s_cmp_lt_u32 s40, 6
    s_cselect_b64 s[52:53], s[24:25], s[52:53]
    s_cselect_b32 s62, 128, s62
    s_cselect_b32 s63, 81920, s63
    s_mov_b32 s54, 2211840
    s_mov_b32 s55, 0x20000
    v_and_b32 v2, 3, v1
    s_lshl_b32 s64, s41, 2
    v_add_u32 v2, s64, v2
    v_min_u32 v2, 26, v2
    v_mul_lo_u32 v2, v2, s63
    v_lshrrev_b32 v3, 2, v1
    s_mul_i32 s64, s42, 24
    v_add_u32 v3, s64, v3
    v_mul_lo_u32 v3, v3, s62
    v_add_u32 v178, v2, v3
    s_lshl_b32 s62, s62, 4
    v_subrev_u32 v2, 256, v0
    v_lshrrev_b32 v3, 3, v2
    v_mul_u32_u24 v3, 27392, v3
    v_and_b32 v2, 7, v2
    v_lshl_add_u32 v3, v2, 4, v3
    s_lshl_b32 s63, s44, 7
    s_add_u32 s63, s63, 3506176
    v_mov_b64 v[84:85], 0
    v_mov_b64 v[86:87], 0
    v_mov_b32 v180, 101776
    v_mov_b32 v181, 1
    s_cmp_lt_u32 s40, 6
    s_barrier
    s_cbranch_scc1 L_pf45
    buffer_load_dword v176, v178, s[52:55], 0 offen
    s_mov_b32 exec_hi, 0
    buffer_load_dword v177, v178, s[52:55], s62 offen
    s_mov_b64 exec, -1
    s_mov_b64 exec, 1
    ds_add_u32 v180, v181 offset:28
    s_mov_b64 exec, -1
    s_branch L_nopf
L_pf45:
L_lw_24:
    ds_read_b32 v181, v180 offset:28
    s_waitcnt lgkmcnt(0)
    v_cmp_gt_u32 vcc, 2, v181
    s_cbranch_vccnz L_lw_24
    buffer_load_dword v176, v178, s[52:55], 0 offen
    s_mov_b32 exec_hi, 0
    buffer_load_dword v177, v178, s[52:55], s62 offen
    s_mov_b64 exec, -1
L_nopf:
    s_waitcnt vmcnt(0)
    buffer_store_dwordx4 v[84:87], v3, s[36:39], s63 offen sc1
    s_add_u32 s63, s63, 876544
    buffer_store_dwordx4 v[84:87], v3, s[36:39], s63 offen sc1
    s_add_u32 s63, s63, 876544
    buffer_store_dwordx4 v[84:87], v3, s[36:39], s63 offen sc1
    s_add_u32 s63, s63, 876544
    buffer_store_dwordx4 v[84:87], v3, s[36:39], s63 offen sc1
    s_waitcnt vmcnt(0)
    s_branch L_b4join
L_nonconv:
    s_cmp_eq_u32 s47, 1
    s_cbranch_scc1 L_moe
    s_waitcnt lgkmcnt(0)
    s_barrier
    s_cmp_ge_u32 s40, 3
    s_cbranch_scc1 L_p3pre
    s_cmp_lg_u32 s42, 31
    s_cbranch_scc1 L_done
    s_cmp_eq_u32 s40, 2
    s_cbranch_scc1 L_done
    s_branch L_router
L_moe:
    s_lshl_b32 s60, s40, 7
    s_lshl_b32 s61, s40, 5
    s_add_u32 s61, s61, 384
    s_cmp_lt_u32 s40, 4
    s_cselect_b32 s60, s60, s61
    v_and_b32 v5, 15, v1
    v_lshrrev_b32 v6, 4, v1
    v_lshl_add_u32 v2, v6, 3, s60
    v_mul_u32_u24 v2, 3456, v2
    v_and_b32 v3, 7, v1
    v_lshl_add_u32 v2, v3, 4, v2
    s_lshl_b32 s62, s44, 7
    v_add_u32 v2, s62, v2
    v_and_b32 v3, 8, v1
    v_cmp_ne_u32 vcc, 0, v3
    v_mov_b32 v240, s20
    v_mov_b32 v241, s21
    v_mov_b32 v3, s22
    v_mov_b32 v4, s23
    v_cndmask_b32 v240, v240, v3, vcc
    v_cndmask_b32 v241, v241, v4, vcc
    v_add_co_u32 v240, vcc, v240, v2
    s_nop 1
    v_addc_co_u32 v241, vcc, 0, v241, vcc
    s_mov_b32 s62, 6912
    s_mov_b32 s63, 0
    s_mov_b32 s64, 89856
    s_mov_b32 s65, 0
    s_cmp_lt_u32 s40, 4
    s_cbranch_scc1 L_mp
    s_setprio 2
L_mp:
    s_waitcnt lgkmcnt(0)
    s_barrier
    s_cmp_ge_u32 s40, 6
    s_cbranch_scc1 L_m0
    global_load_dwordx4 v[200:203], v[240:241], off
    global_load_dwordx4 v[204:207], v[240:241], off offset:3456
    v_lshl_add_u64 v[240:241], v[240:241], 0, s[62:63]
    global_load_dwordx4 v[208:211], v[240:241], off
    global_load_dwordx4 v[212:215], v[240:241], off offset:3456
    v_lshl_add_u64 v[240:241], v[240:241], 0, s[62:63]
    global_load_dwordx4 v[216:219], v[240:241], off
    global_load_dwordx4 v[220:223], v[240:241], off offset:3456
    v_lshl_add_u64 v[240:241], v[240:241], 0, s[62:63]
    global_load_dwordx4 v[224:227], v[240:241], off
    global_load_dwordx4 v[228:231], v[240:241], off offset:3456
    v_lshl_add_u64 v[240:241], v[240:241], 0, s[64:65]
L_m0:
    s_cmp_ge_u32 s40, 4
    s_cbranch_scc1 L_m1
    global_load_dwordx4 v[104:107], v[240:241], off
    global_load_dwordx4 v[108:111], v[240:241], off offset:3456
    v_lshl_add_u64 v[240:241], v[240:241], 0, s[62:63]
    global_load_dwordx4 v[112:115], v[240:241], off
    global_load_dwordx4 v[116:119], v[240:241], off offset:3456
    v_lshl_add_u64 v[240:241], v[240:241], 0, s[62:63]
    global_load_dwordx4 v[120:123], v[240:241], off
    global_load_dwordx4 v[124:127], v[240:241], off offset:3456
    v_lshl_add_u64 v[240:241], v[240:241], 0, s[62:63]
    global_load_dwordx4 v[128:131], v[240:241], off
    global_load_dwordx4 v[132:135], v[240:241], off offset:3456
    v_lshl_add_u64 v[240:241], v[240:241], 0, s[64:65]
    global_load_dwordx4 v[136:139], v[240:241], off
    global_load_dwordx4 v[140:143], v[240:241], off offset:3456
    v_lshl_add_u64 v[240:241], v[240:241], 0, s[62:63]
    global_load_dwordx4 v[144:147], v[240:241], off
    global_load_dwordx4 v[148:151], v[240:241], off offset:3456
    v_lshl_add_u64 v[240:241], v[240:241], 0, s[62:63]
    global_load_dwordx4 v[152:155], v[240:241], off
    global_load_dwordx4 v[156:159], v[240:241], off offset:3456
    v_lshl_add_u64 v[240:241], v[240:241], 0, s[62:63]
    global_load_dwordx4 v[160:163], v[240:241], off
    global_load_dwordx4 v[164:167], v[240:241], off offset:3456
    v_lshl_add_u64 v[240:241], v[240:241], 0, s[64:65]
    global_load_dwordx4 v[168:171], v[240:241], off
    global_load_dwordx4 v[172:175], v[240:241], off offset:3456
    v_lshl_add_u64 v[240:241], v[240:241], 0, s[62:63]
    global_load_dwordx4 v[176:179], v[240:241], off
    global_load_dwordx4 v[180:183], v[240:241], off offset:3456
    v_lshl_add_u64 v[240:241], v[240:241], 0, s[62:63]
    global_load_dwordx4 v[184:187], v[240:241], off
    global_load_dwordx4 v[188:191], v[240:241], off offset:3456
    v_lshl_add_u64 v[240:241], v[240:241], 0, s[62:63]
    global_load_dwordx4 v[192:195], v[240:241], off
    global_load_dwordx4 v[196:199], v[240:241], off offset:3456
    v_mov_b32 v2, 101776
    v_mov_b32 v3, 1
    s_mov_b64 exec, 1
    ds_add_u32 v2, v3 offset:24
    s_mov_b64 exec, -1
    s_waitcnt vmcnt(24)
    s_branch L_m2
L_m1:
    s_waitcnt vmcnt(0)
L_m2:
    s_mov_b32 s62, 0x05040100
    s_mov_b32 s63, 0x07060302
    v_and_b32 v2, 1, v5
    v_mul_u32_u24 v243, 1296, v2
    v_lshl_add_u32 v243, v6, 4, v243
    s_lshl_b32 s60, s60, 1
    v_add_u32 v243, s60, v243
    v_lshlrev_b32 v2, 7, v2
    v_lshl_add_u32 v7, v6, 4, v2
    s_mov_b32 s48, s24
    s_mov_b32 s49, s25
    s_mov_b32 s50, 2211840
    s_mov_b32 s51, 0x20000
    v_mul_u32_u24 v242, 10240, v6
    v_lshl_add_u32 v242, v5, 4, v242
    s_mul_i32 s60, s44, 81920
    s_lshl_b32 s61, s40, 8
    s_add_u32 s60, s60, s61
    v_perm_b32 v72, v204, v200, s62
    v_perm_b32 v76, v204, v200, s63
    v_perm_b32 v73, v212, v208, s62
    v_perm_b32 v77, v212, v208, s63
    v_perm_b32 v74, v220, v216, s62
    v_perm_b32 v78, v220, v216, s63
    v_perm_b32 v75, v228, v224, s62
    v_perm_b32 v79, v228, v224, s63
    v_perm_b32 v80, v205, v201, s62
    v_perm_b32 v84, v205, v201, s63
    v_perm_b32 v81, v213, v209, s62
    v_perm_b32 v85, v213, v209, s63
    v_perm_b32 v82, v221, v217, s62
    v_perm_b32 v86, v221, v217, s63
    v_perm_b32 v83, v229, v225, s62
    v_perm_b32 v87, v229, v225, s63
    v_perm_b32 v88, v206, v202, s62
    v_perm_b32 v92, v206, v202, s63
    v_perm_b32 v89, v214, v210, s62
    v_perm_b32 v93, v214, v210, s63
    v_perm_b32 v90, v222, v218, s62
    v_perm_b32 v94, v222, v218, s63
    v_perm_b32 v91, v230, v226, s62
    v_perm_b32 v95, v230, v226, s63
    v_perm_b32 v96, v207, v203, s62
    v_perm_b32 v100, v207, v203, s63
    v_perm_b32 v97, v215, v211, s62
    v_perm_b32 v101, v215, v211, s63
    v_perm_b32 v98, v223, v219, s62
    v_perm_b32 v102, v223, v219, s63
    v_perm_b32 v99, v231, v227, s62
    v_perm_b32 v103, v231, v227, s63
    s_cmp_gt_u32 s40, 4
    s_cbranch_scc1 L_mx
    s_cmp_eq_u32 s40, 4
    s_cbranch_scc1 L_md
    s_waitcnt vmcnt(16)
    v_perm_b32 v200, v108, v104, s62
    v_perm_b32 v204, v108, v104, s63
    v_perm_b32 v201, v116, v112, s62
    v_perm_b32 v205, v116, v112, s63
    v_perm_b32 v202, v124, v120, s62
    v_perm_b32 v206, v124, v120, s63
    v_perm_b32 v203, v132, v128, s62
    v_perm_b32 v207, v132, v128, s63
    v_perm_b32 v208, v109, v105, s62
    v_perm_b32 v212, v109, v105, s63
    v_perm_b32 v209, v117, v113, s62
    v_perm_b32 v213, v117, v113, s63
    v_perm_b32 v210, v125, v121, s62
    v_perm_b32 v214, v125, v121, s63
    v_perm_b32 v211, v133, v129, s62
    v_perm_b32 v215, v133, v129, s63
    v_perm_b32 v216, v110, v106, s62
    v_perm_b32 v220, v110, v106, s63
    v_perm_b32 v217, v118, v114, s62
    v_perm_b32 v221, v118, v114, s63
    v_perm_b32 v218, v126, v122, s62
    v_perm_b32 v222, v126, v122, s63
    v_perm_b32 v219, v134, v130, s62
    v_perm_b32 v223, v134, v130, s63
    v_perm_b32 v224, v111, v107, s62
    v_perm_b32 v228, v111, v107, s63
    v_perm_b32 v225, v119, v115, s62
    v_perm_b32 v229, v119, v115, s63
    v_perm_b32 v226, v127, v123, s62
    v_perm_b32 v230, v127, v123, s63
    v_perm_b32 v227, v135, v131, s62
    v_perm_b32 v231, v135, v131, s63
    buffer_load_dwordx4 v[8:11], v242, s[48:51], s60 offen offset:0
    buffer_load_dwordx4 v[12:15], v242, s[48:51], s60 offen offset:1280
    buffer_load_dwordx4 v[16:19], v242, s[48:51], s60 offen offset:2560
    buffer_load_dwordx4 v[20:23], v242, s[48:51], s60 offen offset:3840
    s_add_u32 s60, s60, 5120
    s_waitcnt vmcnt(12)
    v_perm_b32 v104, v140, v136, s62
    v_perm_b32 v108, v140, v136, s63
    v_perm_b32 v105, v148, v144, s62
    v_perm_b32 v109, v148, v144, s63
    v_perm_b32 v106, v156, v152, s62
    v_perm_b32 v110, v156, v152, s63
    v_perm_b32 v107, v164, v160, s62
    v_perm_b32 v111, v164, v160, s63
    v_perm_b32 v112, v141, v137, s62
    v_perm_b32 v116, v141, v137, s63
    v_perm_b32 v113, v149, v145, s62
    v_perm_b32 v117, v149, v145, s63
    v_perm_b32 v114, v157, v153, s62
    v_perm_b32 v118, v157, v153, s63
    v_perm_b32 v115, v165, v161, s62
    v_perm_b32 v119, v165, v161, s63
    v_perm_b32 v120, v142, v138, s62
    v_perm_b32 v124, v142, v138, s63
    v_perm_b32 v121, v150, v146, s62
    v_perm_b32 v125, v150, v146, s63
    v_perm_b32 v122, v158, v154, s62
    v_perm_b32 v126, v158, v154, s63
    v_perm_b32 v123, v166, v162, s62
    v_perm_b32 v127, v166, v162, s63
    v_perm_b32 v128, v143, v139, s62
    v_perm_b32 v132, v143, v139, s63
    v_perm_b32 v129, v151, v147, s62
    v_perm_b32 v133, v151, v147, s63
    v_perm_b32 v130, v159, v155, s62
    v_perm_b32 v134, v159, v155, s63
    v_perm_b32 v131, v167, v163, s62
    v_perm_b32 v135, v167, v163, s63
    buffer_load_dwordx4 v[24:27], v242, s[48:51], s60 offen offset:0
    buffer_load_dwordx4 v[28:31], v242, s[48:51], s60 offen offset:1280
    buffer_load_dwordx4 v[32:35], v242, s[48:51], s60 offen offset:2560
    buffer_load_dwordx4 v[36:39], v242, s[48:51], s60 offen offset:3840
    s_add_u32 s60, s60, 35840
    buffer_load_dwordx4 v[40:43], v242, s[48:51], s60 offen offset:0
    buffer_load_dwordx4 v[44:47], v242, s[48:51], s60 offen offset:1280
    s_waitcnt vmcnt(10)
    v_perm_b32 v136, v172, v168, s62
    v_perm_b32 v140, v172, v168, s63
    v_perm_b32 v137, v180, v176, s62
    v_perm_b32 v141, v180, v176, s63
    v_perm_b32 v138, v188, v184, s62
    v_perm_b32 v142, v188, v184, s63
    v_perm_b32 v139, v196, v192, s62
    v_perm_b32 v143, v196, v192, s63
    v_perm_b32 v144, v173, v169, s62
    v_perm_b32 v148, v173, v169, s63
    v_perm_b32 v145, v181, v177, s62
    v_perm_b32 v149, v181, v177, s63
    v_perm_b32 v146, v189, v185, s62
    v_perm_b32 v150, v189, v185, s63
    v_perm_b32 v147, v197, v193, s62
    v_perm_b32 v151, v197, v193, s63
    v_perm_b32 v152, v174, v170, s62
    v_perm_b32 v156, v174, v170, s63
    v_perm_b32 v153, v182, v178, s62
    v_perm_b32 v157, v182, v178, s63
    v_perm_b32 v154, v190, v186, s62
    v_perm_b32 v158, v190, v186, s63
    v_perm_b32 v155, v198, v194, s62
    v_perm_b32 v159, v198, v194, s63
    v_perm_b32 v160, v175, v171, s62
    v_perm_b32 v164, v175, v171, s63
    v_perm_b32 v161, v183, v179, s62
    v_perm_b32 v165, v183, v179, s63
    v_perm_b32 v162, v191, v187, s62
    v_perm_b32 v166, v191, v187, s63
    v_perm_b32 v163, v199, v195, s62
    v_perm_b32 v167, v199, v195, s63
    buffer_load_dwordx4 v[48:51], v242, s[48:51], s60 offen offset:2560
    buffer_load_dwordx4 v[52:55], v242, s[48:51], s60 offen offset:3840
    s_add_u32 s60, s60, 5120
    buffer_load_dwordx4 v[56:59], v242, s[48:51], s60 offen offset:0
    buffer_load_dwordx4 v[60:63], v242, s[48:51], s60 offen offset:1280
    buffer_load_dwordx4 v[64:67], v242, s[48:51], s60 offen offset:2560
    buffer_load_dwordx4 v[68:71], v242, s[48:51], s60 offen offset:3840
    s_add_u32 s60, s60, 35840
    s_branch L_mb2
L_md:
    s_setprio 0
    v_mov_b32 v3, 101776
L_lw_26:
    ds_read_b32 v2, v3 offset:24
    s_waitcnt lgkmcnt(0)
    v_cmp_gt_u32 vcc, 4, v2
    s_cbranch_vccnz L_lw_26
    buffer_load_dwordx4 v[8:11], v242, s[48:51], s60 offen offset:0
    buffer_load_dwordx4 v[12:15], v242, s[48:51], s60 offen offset:1280
    buffer_load_dwordx4 v[16:19], v242, s[48:51], s60 offen offset:2560
    buffer_load_dwordx4 v[20:23], v242, s[48:51], s60 offen offset:3840
    s_add_u32 s60, s60, 5120
    buffer_load_dwordx4 v[24:27], v242, s[48:51], s60 offen offset:0
    buffer_load_dwordx4 v[28:31], v242, s[48:51], s60 offen offset:1280
    buffer_load_dwordx4 v[32:35], v242, s[48:51], s60 offen offset:2560
    buffer_load_dwordx4 v[36:39], v242, s[48:51], s60 offen offset:3840
    s_add_u32 s60, s60, 35840
    buffer_load_dwordx4 v[40:43], v242, s[48:51], s60 offen offset:0
    buffer_load_dwordx4 v[44:47], v242, s[48:51], s60 offen offset:1280
    buffer_load_dwordx4 v[48:51], v242, s[48:51], s60 offen offset:2560
    buffer_load_dwordx4 v[52:55], v242, s[48:51], s60 offen offset:3840
    s_add_u32 s60, s60, 5120
    buffer_load_dwordx4 v[56:59], v242, s[48:51], s60 offen offset:0
    buffer_load_dwordx4 v[60:63], v242, s[48:51], s60 offen offset:1280
    buffer_load_dwordx4 v[64:67], v242, s[48:51], s60 offen offset:2560
    buffer_load_dwordx4 v[68:71], v242, s[48:51], s60 offen offset:3840
    s_add_u32 s60, s60, 35840
L_mb2:
    v_mov_b32 v3, v243
    s_lshl_b32 s64, s40, 12
    v_lshl_add_u32 v4, v1, 3, s64
    s_waitcnt lgkmcnt(0)
    s_barrier
    ds_read_b128 v[232:235], v3 offset:0
    ds_read_b128 v[236:239], v3 offset:64
    ds_read_b128 v[240:243], v3 offset:128
    ds_read_b128 v[244:247], v3 offset:192
    s_waitcnt lgkmcnt(3)
    v_mfma_f32_16x16x32_bf16 v[168:171], v[232:235], v[72:75], 0
    v_mfma_f32_16x16x32_bf16 v[172:175], v[232:235], v[76:79], 0
    v_mfma_f32_16x16x32_bf16 v[176:179], v[232:235], v[80:83], 0
    v_mfma_f32_16x16x32_bf16 v[180:183], v[232:235], v[84:87], 0
    v_mfma_f32_16x16x32_bf16 v[184:187], v[232:235], v[88:91], 0
    v_mfma_f32_16x16x32_bf16 v[188:191], v[232:235], v[92:95], 0
    v_mfma_f32_16x16x32_bf16 v[192:195], v[232:235], v[96:99], 0
    v_mfma_f32_16x16x32_bf16 v[196:199], v[232:235], v[100:103], 0
    s_cmp_ge_u32 s40, 4
    s_cbranch_scc1 L_mr
    s_waitcnt lgkmcnt(0)
    v_mfma_f32_16x16x32_bf16 v[168:171], v[236:239], v[200:203], v[168:171]
    v_mfma_f32_16x16x32_bf16 v[168:171], v[240:243], v[104:107], v[168:171]
    v_mfma_f32_16x16x32_bf16 v[168:171], v[244:247], v[136:139], v[168:171]
    v_mfma_f32_16x16x32_bf16 v[172:175], v[236:239], v[204:207], v[172:175]
    v_mfma_f32_16x16x32_bf16 v[172:175], v[240:243], v[108:111], v[172:175]
    v_mfma_f32_16x16x32_bf16 v[172:175], v[244:247], v[140:143], v[172:175]
    v_mfma_f32_16x16x32_bf16 v[176:179], v[236:239], v[208:211], v[176:179]
    v_mfma_f32_16x16x32_bf16 v[176:179], v[240:243], v[112:115], v[176:179]
    v_mfma_f32_16x16x32_bf16 v[176:179], v[244:247], v[144:147], v[176:179]
    v_mfma_f32_16x16x32_bf16 v[180:183], v[236:239], v[212:215], v[180:183]
    v_mfma_f32_16x16x32_bf16 v[180:183], v[240:243], v[116:119], v[180:183]
    v_mfma_f32_16x16x32_bf16 v[180:183], v[244:247], v[148:151], v[180:183]
    ds_write_b64 v4, v[168:169] offset:4096
    v_mfma_f32_16x16x32_bf16 v[184:187], v[236:239], v[216:219], v[184:187]
    v_mfma_f32_16x16x32_bf16 v[184:187], v[240:243], v[120:123], v[184:187]
    v_mfma_f32_16x16x32_bf16 v[184:187], v[244:247], v[152:155], v[184:187]
    ds_write_b64 v4, v[172:173] offset:4608
    v_mfma_f32_16x16x32_bf16 v[188:191], v[236:239], v[220:223], v[188:191]
    v_mfma_f32_16x16x32_bf16 v[188:191], v[240:243], v[124:127], v[188:191]
    v_mfma_f32_16x16x32_bf16 v[188:191], v[244:247], v[156:159], v[188:191]
    ds_write_b64 v4, v[176:177] offset:5120
    v_mfma_f32_16x16x32_bf16 v[192:195], v[236:239], v[224:227], v[192:195]
    v_mfma_f32_16x16x32_bf16 v[192:195], v[240:243], v[128:131], v[192:195]
    v_mfma_f32_16x16x32_bf16 v[192:195], v[244:247], v[160:163], v[192:195]
    ds_write_b64 v4, v[180:181] offset:5632
    v_mfma_f32_16x16x32_bf16 v[196:199], v[236:239], v[228:231], v[196:199]
    v_mfma_f32_16x16x32_bf16 v[196:199], v[240:243], v[132:135], v[196:199]
    v_mfma_f32_16x16x32_bf16 v[196:199], v[244:247], v[164:167], v[196:199]
    ds_write_b64 v4, v[184:185] offset:6144
    s_nop 0
    ds_write_b64 v4, v[188:189] offset:6656
    s_nop 1
    ds_write_b64 v4, v[192:193] offset:7168
    s_nop 2
    ds_write_b64 v4, v[196:197] offset:7680
    s_branch L_mr2
L_mr:
    ds_write_b64 v4, v[168:169] offset:4096
    ds_write_b64 v4, v[172:173] offset:4608
    ds_write_b64 v4, v[176:177] offset:5120
    ds_write_b64 v4, v[180:181] offset:5632
    ds_write_b64 v4, v[184:185] offset:6144
    ds_write_b64 v4, v[188:189] offset:6656
    ds_write_b64 v4, v[192:193] offset:7168
    ds_write_b64 v4, v[196:197] offset:7680
L_mr2:
    s_waitcnt lgkmcnt(0)
    s_barrier
    s_cmp_gt_u32 s40, 4
    s_cbranch_scc1 L_mh
    v_lshrrev_b32 v240, 5, v1
    s_lshl_b32 s64, s41, 7
    s_add_u32 s64, s64, 7028736
    v_lshl_add_u32 v241, v240, 6, s64
    buffer_load_dwordx4 v[244:247], v241, s[36:39], 0 offen sc1
    s_waitcnt vmcnt(9)
    v_perm_b32 v72, v12, v8, s62
    v_perm_b32 v76, v12, v8, s63
    v_perm_b32 v73, v20, v16, s62
    v_perm_b32 v77, v20, v16, s63
    v_perm_b32 v74, v28, v24, s62
    v_perm_b32 v78, v28, v24, s63
    v_perm_b32 v75, v36, v32, s62
    v_perm_b32 v79, v36, v32, s63
    v_perm_b32 v80, v13, v9, s62
    v_perm_b32 v84, v13, v9, s63
    v_perm_b32 v81, v21, v17, s62
    v_perm_b32 v85, v21, v17, s63
    v_perm_b32 v82, v29, v25, s62
    v_perm_b32 v86, v29, v25, s63
    v_perm_b32 v83, v37, v33, s62
    v_perm_b32 v87, v37, v33, s63
    v_perm_b32 v88, v14, v10, s62
    v_perm_b32 v92, v14, v10, s63
    v_perm_b32 v89, v22, v18, s62
    v_perm_b32 v93, v22, v18, s63
    v_perm_b32 v90, v30, v26, s62
    v_perm_b32 v94, v30, v26, s63
    v_perm_b32 v91, v38, v34, s62
    v_perm_b32 v95, v38, v34, s63
    v_perm_b32 v96, v15, v11, s62
    v_perm_b32 v100, v15, v11, s63
    v_perm_b32 v97, v23, v19, s62
    v_perm_b32 v101, v23, v19, s63
    v_perm_b32 v98, v31, v27, s62
    v_perm_b32 v102, v31, v27, s63
    v_perm_b32 v99, v39, v35, s62
    v_perm_b32 v103, v39, v35, s63
    s_waitcnt vmcnt(1)
    v_perm_b32 v104, v44, v40, s62
    v_perm_b32 v108, v44, v40, s63
    v_perm_b32 v105, v52, v48, s62
    v_perm_b32 v109, v52, v48, s63
    v_perm_b32 v106, v60, v56, s62
    v_perm_b32 v110, v60, v56, s63
    v_perm_b32 v107, v68, v64, s62
    v_perm_b32 v111, v68, v64, s63
    v_perm_b32 v112, v45, v41, s62
    v_perm_b32 v116, v45, v41, s63
    v_perm_b32 v113, v53, v49, s62
    v_perm_b32 v117, v53, v49, s63
    v_perm_b32 v114, v61, v57, s62
    v_perm_b32 v118, v61, v57, s63
    v_perm_b32 v115, v69, v65, s62
    v_perm_b32 v119, v69, v65, s63
    v_perm_b32 v120, v46, v42, s62
    v_perm_b32 v124, v46, v42, s63
    v_perm_b32 v121, v54, v50, s62
    v_perm_b32 v125, v54, v50, s63
    v_perm_b32 v122, v62, v58, s62
    v_perm_b32 v126, v62, v58, s63
    v_perm_b32 v123, v70, v66, s62
    v_perm_b32 v127, v70, v66, s63
    v_perm_b32 v128, v47, v43, s62
    v_perm_b32 v132, v47, v43, s63
    v_perm_b32 v129, v55, v51, s62
    v_perm_b32 v133, v55, v51, s63
    v_perm_b32 v130, v63, v59, s62
    v_perm_b32 v134, v63, v59, s63
    v_perm_b32 v131, v71, v67, s62
    v_perm_b32 v135, v71, v67, s63
    s_mul_i32 s64, s44, 10240
    s_lshl_b32 s65, s40, 11
    s_add_u32 s64, s64, s65
    s_add_u32 s64, s64, 7062656
    v_lshlrev_b32 v2, 4, v5
    s_barrier
    ds_read_b128 v[232:235], v7 offset:2592
    ds_read_b128 v[236:239], v7 offset:2656
    s_waitcnt lgkmcnt(0)
    v_mfma_f32_16x16x32_bf16 v[168:171], v[232:235], v[72:75], 0
    v_mfma_f32_16x16x32_bf16 v[168:171], v[236:239], v[104:107], v[168:171]
    v_mfma_f32_16x16x32_bf16 v[172:175], v[232:235], v[76:79], 0
    v_mfma_f32_16x16x32_bf16 v[172:175], v[236:239], v[108:111], v[172:175]
    v_mfma_f32_16x16x32_bf16 v[176:179], v[232:235], v[80:83], 0
    v_mfma_f32_16x16x32_bf16 v[176:179], v[236:239], v[112:115], v[176:179]
    v_mfma_f32_16x16x32_bf16 v[180:183], v[232:235], v[84:87], 0
    v_mfma_f32_16x16x32_bf16 v[180:183], v[236:239], v[116:119], v[180:183]
    v_mfma_f32_16x16x32_bf16 v[184:187], v[232:235], v[88:91], 0
    v_mfma_f32_16x16x32_bf16 v[184:187], v[236:239], v[120:123], v[184:187]
    v_mfma_f32_16x16x32_bf16 v[188:191], v[232:235], v[92:95], 0
    v_mfma_f32_16x16x32_bf16 v[188:191], v[236:239], v[124:127], v[188:191]
    v_mfma_f32_16x16x32_bf16 v[192:195], v[232:235], v[96:99], 0
    v_mfma_f32_16x16x32_bf16 v[192:195], v[236:239], v[128:131], v[192:195]
    v_mfma_f32_16x16x32_bf16 v[196:199], v[232:235], v[100:103], 0
    v_mfma_f32_16x16x32_bf16 v[196:199], v[236:239], v[132:135], v[196:199]
    s_mov_b64 exec, 0xffff
    v_mov_b32 v171, s45
    buffer_store_dwordx4 v[168:171], v2, s[36:39], s64 offen offset:0 sc1
    v_mov_b32 v175, s45
    buffer_store_dwordx4 v[172:175], v2, s[36:39], s64 offen offset:256 sc1
    v_mov_b32 v179, s45
    buffer_store_dwordx4 v[176:179], v2, s[36:39], s64 offen offset:512 sc1
    v_mov_b32 v183, s45
    buffer_store_dwordx4 v[180:183], v2, s[36:39], s64 offen offset:768 sc1
    v_mov_b32 v187, s45
    buffer_store_dwordx4 v[184:187], v2, s[36:39], s64 offen offset:1024 sc1
    v_mov_b32 v191, s45
    buffer_store_dwordx4 v[188:191], v2, s[36:39], s64 offen offset:1280 sc1
    s_nop 0
    v_mov_b32 v195, s45
    buffer_store_dwordx4 v[192:195], v2, s[36:39], s64 offen offset:1536 sc1
    v_mov_b32 v199, s45
    buffer_store_dwordx4 v[196:199], v2, s[36:39], s64 offen offset:1792 sc1
    s_mov_b64 exec, -1
    s_cmp_ge_u32 s40, 3
    s_cbranch_scc1 L_p3pre
    s_mul_i32 s60, s44, 3
    s_add_u32 s60, s60, s40
    s_cmp_ge_u32 s60, 80
    s_cbranch_scc1 L_done
    v_and_b32 v4, 7, v1
    s_lshl_b32 s62, s60, 3
    v_add_u32 v4, s62, v4
    v_and_b32 v32, 0x380, v4
    v_and_b32 v2, 15, v4
    v_lshl_add_u32 v32, v2, 3, v32
    v_bfe_u32 v2, v4, 4, 3
    v_add_u32 v32, v32, v2
    v_mul_u32_u24 v2, 1296, v240
    v_lshl_add_u32 v2, v32, 1, v2
    ds_read_u16 v34, v2 offset:0
    v_lshlrev_b32 v4, 4, v4
    v_add_u32 v4, 7062656, v4
    v_lshrrev_b32 v2, 3, v1
    v_mul_u32_u24 v40, 10240, v2
    v_add_u32 v40, v40, v4
    v_min_u32 v2, 2, v2
    v_mul_u32_u24 v41, 10240, v2
    v_add_u32 v41, v41, v4
    s_mov_b32 s48, s26
    s_mov_b32 s49, s27
    s_mov_b32 s50, 2621440
    s_mov_b32 s51, 0x20000
    s_waitcnt vmcnt(8) lgkmcnt(0)
    v_cmp_ne_u32 vcc, s45, v247
    s_cbranch_vccz L_tok
    s_mov_b32 s68, 200000
    s_mov_b64 s[66:67], exec
L_poll_27:
    buffer_load_dwordx4 v[244:247], v241, s[36:39], 0 offen sc1
    s_waitcnt vmcnt(0)
    v_cmpx_eq_u32 vcc, s45, v247
    s_andn2_b64 s[66:67], s[66:67], exec
    s_cbranch_scc0 L_pollx_28
    s_mov_b64 exec, s[66:67]
    s_sub_u32 s68, s68, 1
    s_sleep 2
    s_cmp_lg_u32 s68, 0
    s_cbranch_scc1 L_poll_27
L_pollx_28:
    s_mov_b64 exec, -1
L_tok:
    s_mov_b32 exec_lo, 0
    v_mov_b32 v244, v245
    s_mov_b64 exec, -1
    v_not_b32 v39, v244
    v_and_b32 v39, 0xffff, v39
    v_mul_u32_u24 v38, 1280, v39
    v_lshl_add_u32 v38, v32, 1, v38
    buffer_load_ushort v33, v38, s[32:35], 0 offen
    v_bfe_u32 v3, v39, 1, 2
    v_lshl_add_u32 v3, v32, 2, v3
    s_mov_b32 s62, 0x55555556
    v_mul_hi_u32 v4, v3, s62
    v_mul_u32_u24 v36, 3, v4
    v_sub_u32 v36, v3, v36
    v_lshrrev_b32 v35, 4, v39
    v_mul_u32_u24 v35, 27392, v35
    v_and_b32 v3, 0xffc, v4
    v_add_u32 v4, v4, v3
    v_lshl_add_u32 v35, v4, 4, v35
    v_and_b32 v3, 8, v39
    v_lshl_add_u32 v35, v3, 3, v35
    v_add_u32 v35, 3506176, v35
    s_waitcnt vmcnt(1)
    s_mov_b32 s68, 200000
    s_mov_b64 s[66:67], exec
L_poll_29:
    s_mov_b32 s63, 0
    buffer_load_dwordx4 v[8:11], v40, s[36:39], s63 offen sc1
    s_mov_b32 s63, 81920
    buffer_load_dwordx4 v[12:15], v40, s[36:39], s63 offen sc1
    s_mov_b32 s63, 163840
    buffer_load_dwordx4 v[16:19], v40, s[36:39], s63 offen sc1
    s_mov_b32 s63, 245760
    buffer_load_dwordx4 v[20:23], v41, s[36:39], s63 offen sc1
    buffer_load_dwordx4 v[28:31], v35, s[36:39], 0 offen sc1
    s_waitcnt vmcnt(0)
    v_cmpx_eq_u32 vcc, s45, v11
    v_cmpx_eq_u32 vcc, s45, v15
    v_cmpx_eq_u32 vcc, s45, v19
    v_cmpx_eq_u32 vcc, s45, v23
    v_cmpx_eq_u32 vcc, s45, v31
    s_andn2_b64 s[66:67], s[66:67], exec
    s_cbranch_scc0 L_pollx_30
    s_mov_b64 exec, s[66:67]
    s_sub_u32 s68, s68, 1
    s_sleep 1
    s_cmp_lg_u32 s68, 0
    s_cbranch_scc1 L_poll_29
L_pollx_30:
    s_mov_b64 exec, -1
    v_pk_add_f32 v[8:9], v[8:9], v[12:13]
    v_mov_b32 v37, v246
    v_pk_add_f32 v[8:9], v[8:9], v[16:17]
    s_mov_b64 exec, 0xffffff
    v_pk_add_f32 v[8:9], v[8:9], v[20:21]
    s_mov_b64 exec, -1
    v_mul_f32 v37, 0xbfb8aa3b, v37
    v_exp_f32 v37, v37
    v_permlane32_swap_b32 v8, v9
    v_add_f32 v37, 1.0, v37
    v_add_f32 v8, v8, v9
    v_rcp_f32 v37, v37
    v_mov_b32 v9, v8
    v_cmp_eq_u32 vcc, 1, v36
    v_cmp_eq_u32 s[64:65], 2, v36
    v_permlane16_swap_b32 v8, v9
    v_cvt_pk_bf16_f32 v37, v37, v37
    v_add_f32 v8, v8, v9
    v_cndmask_b32 v28, v28, v29, vcc
    v_cndmask_b32 v28, v28, v30, s[64:65]
    v_add_f32_dpp v8, v8, v8 row_ror:8 row_mask:0xf bank_mask:0xf
    v_lshlrev_b32 v37, 16, v37
    v_and_b32 v3, 1, v39
    v_lshlrev_b32 v3, 4, v3
    v_lshrrev_b32 v28, v3, v28
    v_lshlrev_b32 v28, 16, v28
    v_lshlrev_b32 v34, 16, v34
    v_lshlrev_b32 v33, 16, v33
    v_mul_f32 v28, v28, v34
    v_cvt_pk_bf16_f32 v2, v8, v28
    v_lshlrev_b32 v8, 16, v2
    v_and_b32 v28, 0xffff0000, v2
    v_mul_f32 v8, v8, v37
    v_add_f32 v28, v28, v33
    v_cvt_pk_bf16_f32 v2, v8, v28
    v_lshlrev_b32 v8, 16, v2
    v_and_b32 v28, 0xffff0000, v2
    v_add_f32 v8, v8, v34
    v_cvt_pk_bf16_f32 v8, v8, v8
    v_lshlrev_b32 v8, 16, v8
    v_add_f32 v28, v28, v8
    v_cvt_pk_bf16_f32 v28, v28, v28
    s_mov_b32 exec_lo, 0xff
    s_mov_b32 exec_hi, 0xff
    buffer_store_short v28, v38, s[48:51], 0 offen
    s_branch L_done
L_mx:
    s_cmp_eq_u32 s40, 7
    s_cbranch_scc1 L_m7
    s_sub_u32 s60, s40, 5
    s_lshl_b32 s61, s60, 11
    s_lshl_b32 s64, s41, 12
    s_add_u32 s61, s61, s64
    s_add_u32 s61, s61, 7029888
    s_mul_i32 s60, s60, 1296
    v_min_u32 v2, 43, v1
    v_add_u32 v2, 64, v2
    v_lshl_add_u32 v8, v1, 4, s61
    v_lshl_add_u32 v9, v2, 4, s61
    v_mul_u32_u24 v10, 12, v1
    v_mul_u32_u24 v11, 12, v2
    v_add_u32 v10, s60, v10
    v_add_u32 v11, s60, v11
    s_mov_b32 s68, 200000
    s_mov_b64 s[66:67], exec
L_poll_31:
    buffer_load_dwordx4 v[12:15], v8, s[36:39], 0 offen sc1
    buffer_load_dwordx4 v[16:19], v9, s[36:39], 0 offen sc1
    s_waitcnt vmcnt(0)
    v_cmpx_eq_u32 vcc, s45, v15
    v_cmpx_eq_u32 vcc, s45, v19
    s_andn2_b64 s[66:67], s[66:67], exec
    s_cbranch_scc0 L_pollx_32
    s_mov_b64 exec, s[66:67]
    s_sub_u32 s68, s68, 1
    s_sleep 2
    s_cmp_lg_u32 s68, 0
    s_cbranch_scc1 L_poll_31
L_pollx_32:
    s_mov_b64 exec, -1
    ds_write2_b32 v10, v12, v13 offset0:0 offset1:1
    ds_write_b32 v10, v14 offset:8
    ds_write2_b32 v11, v16, v17 offset0:0 offset1:1
    ds_write_b32 v11, v18 offset:8
    s_branch L_mb2
L_m7:
    s_mul_i32 s64, s44, 10240
    s_add_u32 s64, s64, 7062656
    v_lshlrev_b32 v2, 4, v1
    v_mov_b64 v[12:13], 0
    v_mov_b64 v[14:15], 0
    buffer_store_dwordx4 v[12:15], v2, s[36:39], s64 offen offset:0 sc1
    buffer_store_dwordx4 v[12:15], v2, s[36:39], s64 offen offset:1024 sc1
    buffer_store_dwordx4 v[12:15], v2, s[36:39], s64 offen offset:2048 sc1
    buffer_store_dwordx4 v[12:15], v2, s[36:39], s64 offen offset:3072 sc1
    s_add_u32 s64, s64, 4096
    buffer_store_dwordx4 v[12:15], v2, s[36:39], s64 offen offset:0 sc1
    buffer_store_dwordx4 v[12:15], v2, s[36:39], s64 offen offset:1024 sc1
    buffer_store_dwordx4 v[12:15], v2, s[36:39], s64 offen offset:2048 sc1
    buffer_store_dwordx4 v[12:15], v2, s[36:39], s64 offen offset:3072 sc1
    s_add_u32 s64, s64, 4096
    buffer_store_dwordx4 v[12:15], v2, s[36:39], s64 offen offset:0 sc1
    buffer_store_dwordx4 v[12:15], v2, s[36:39], s64 offen offset:1024 sc1
    s_waitcnt vmcnt(0)
    s_branch L_mb2
L_mh:
    s_cmp_eq_u32 s40, 7
    s_cbranch_scc1 L_mb4
    v_subrev_u32 v2, 320, v0
    v_lshrrev_b32 v4, 4, v2
    v_and_b32 v2, 15, v2
    v_lshlrev_b32 v3, 9, v4
    v_lshl_add_u32 v3, v2, 2, v3
    v_add_u32 v10, 64, v3
    ds_read2st64_b32 v[20:21], v3 offset0:16 offset1:32
    ds_read2st64_b32 v[28:29], v10 offset0:16 offset1:32
    ds_read2st64_b32 v[22:23], v3 offset0:48 offset1:64
    ds_read2st64_b32 v[30:31], v10 offset0:48 offset1:64
    ds_read2st64_b32 v[24:25], v3 offset0:80 offset1:96
    ds_read2st64_b32 v[32:33], v10 offset0:80 offset1:96
    ds_read2st64_b32 v[26:27], v3 offset0:112 offset1:128
    ds_read2st64_b32 v[34:35], v10 offset0:112 offset1:128
    v_lshlrev_b32 v4, 1, v4
    v_and_b32 v3, 1, v2
    v_lshl_add_u32 v4, v3, 7, v4
    v_and_b32 v2, 14, v2
    v_lshl_add_u32 v2, v2, 3, v4
    s_waitcnt lgkmcnt(0)
    v_pk_add_f32 v[20:21], v[20:21], v[22:23]
    v_pk_add_f32 v[28:29], v[28:29], v[30:31]
    v_pk_add_f32 v[24:25], v[24:25], v[26:27]
    v_pk_add_f32 v[32:33], v[32:33], v[34:35]
    v_pk_add_f32 v[20:21], v[20:21], v[24:25]
    v_pk_add_f32 v[28:29], v[28:29], v[32:33]
    v_add_f32 v20, v20, v21
    v_add_f32 v21, v28, v29
    v_cvt_pk_bf16_f32 v22, v20, v21
    v_lshlrev_b32 v20, 16, v22
    v_and_b32 v21, 0xffff0000, v22
    v_mul_f32 v22, 0xbfb8aa3b, v20
    v_exp_f32 v22, v22
    s_nop 0
    v_add_f32 v22, 1.0, v22
    v_rcp_f32 v22, v22
    s_nop 0
    v_mul_f32 v20, v20, v22
    v_cvt_pk_bf16_f32 v20, v20, v20
    v_lshlrev_b32 v20, 16, v20
    v_mul_f32 v20, v20, v21
    v_cvt_pk_bf16_f32 v22, v20, v20
    ds_write_b16 v2, v22 offset:2592
    s_waitcnt lgkmcnt(0)
L_mb4:
    s_setprio 0
    s_barrier
    s_branch L_p3pre
L_router:
    s_mov_b32 s56, s18
    s_mov_b32 s57, s19
    s_mov_b32 s58, 1280
    s_mov_b32 s59, 0x20000
    v_mul_u32_u24 v14, 12, v1
    buffer_load_dwordx3 v[60:62], v14, s[56:59], 0 offen
    buffer_load_dwordx3 v[64:66], v14, s[56:59], 0 offen offset:768
    v_lshlrev_b32 v12, 6, v1
    v_mov_b32 v55, s45
    v_mov_b32 v59, s45
    v_mov_b32 v51, s45
    s_waitcnt vmcnt(0)
    s_mov_b32 s68, 200000
    s_mov_b64 s[66:67], exec
L_poll_33:
    s_mov_b32 s62, 7012352
    buffer_load_dwordx4 v[16:19], v12, s[36:39], s62 offen sc1
    s_mov_b32 s62, 7016448
    buffer_load_dwordx4 v[20:23], v12, s[36:39], s62 offen sc1
    s_mov_b32 s62, 7020544
    buffer_load_dwordx4 v[24:27], v12, s[36:39], s62 offen sc1
    s_mov_b32 s62, 7024640
    buffer_load_dwordx4 v[28:31], v12, s[36:39], s62 offen sc1
    s_waitcnt vmcnt(0)
    v_cmpx_eq_u32 vcc, s45, v19
    v_cmpx_eq_u32 vcc, s45, v23
    v_cmpx_eq_u32 vcc, s45, v27
    v_cmpx_eq_u32 vcc, s45, v31
    s_andn2_b64 s[66:67], s[66:67], exec
    s_cbranch_scc0 L_pollx_34
    s_mov_b64 exec, s[66:67]
    s_sub_u32 s68, s68, 1
    s_sleep 1
    s_cmp_lg_u32 s68, 0
    s_cbranch_scc1 L_poll_33
L_pollx_34:
    s_mov_b64 exec, -1
    v_mov_b32 v8, v16
    v_mov_b32 v9, v17
    v_min_u32 v2, v8, v20
    v_max_u32 v8, v8, v20
    v_max3_u32 v9, v9, v21, v2
    v_min_u32 v2, v8, v24
    v_max_u32 v8, v8, v24
    v_max3_u32 v9, v9, v25, v2
    v_min_u32 v2, v8, v28
    v_max_u32 v8, v8, v28
    v_max3_u32 v9, v9, v29, v2
    v_mov_b32 v10, 0
    v_mov_b32 v11, 0
    s_nop 0
    v_mov_b32_dpp v10, v8 row_shr:1 row_mask:0xf bank_mask:0xf
    v_mov_b32_dpp v11, v9 row_shr:1 row_mask:0xf bank_mask:0xf
    v_min_u32 v2, v8, v10
    v_max_u32 v8, v8, v10
    v_max3_u32 v9, v9, v11, v2
    v_mov_b32 v10, 0
    v_mov_b32 v11, 0
    s_nop 0
    v_mov_b32_dpp v10, v8 row_shr:2 row_mask:0xf bank_mask:0xf
    v_mov_b32_dpp v11, v9 row_shr:2 row_mask:0xf bank_mask:0xf
    v_min_u32 v2, v8, v10
    v_max_u32 v8, v8, v10
    v_max3_u32 v9, v9, v11, v2
    v_mov_b32 v10, 0
    v_mov_b32 v11, 0
    s_nop 0
    v_mov_b32_dpp v10, v8 row_shr:4 row_mask:0xf bank_mask:0xf
    v_mov_b32_dpp v11, v9 row_shr:4 row_mask:0xf bank_mask:0xf
    v_min_u32 v2, v8, v10
    v_max_u32 v8, v8, v10
    v_max3_u32 v9, v9, v11, v2
    v_mov_b32 v10, 0
    v_mov_b32 v11, 0
    s_nop 0
    v_mov_b32_dpp v10, v8 row_shr:8 row_mask:0xf bank_mask:0xf
    v_mov_b32_dpp v11, v9 row_shr:8 row_mask:0xf bank_mask:0xf
    v_min_u32 v2, v8, v10
    v_max_u32 v8, v8, v10
    v_max3_u32 v9, v9, v11, v2
    v_mov_b32 v10, 0
    v_mov_b32 v11, 0
    s_nop 0
    v_mov_b32_dpp v10, v8 row_bcast:15 row_mask:0xa bank_mask:0xf
    v_mov_b32_dpp v11, v9 row_bcast:15 row_mask:0xa bank_mask:0xf
    v_min_u32 v2, v8, v10
    v_max_u32 v8, v8, v10
    v_max3_u32 v9, v9, v11, v2
    v_mov_b32 v10, 0
    v_mov_b32 v11, 0
    s_nop 0
    v_mov_b32_dpp v10, v8 row_bcast:31 row_mask:0xc bank_mask:0xf
    v_mov_b32_dpp v11, v9 row_bcast:31 row_mask:0xc bank_mask:0xf
    v_min_u32 v2, v8, v10
    v_max_u32 v8, v8, v10
    v_max3_u32 v9, v9, v11, v2
    s_nop 0
    v_readlane_b32 s62, v8, 63
    v_readlane_b32 s63, v9, 63
    s_cmp_eq_u32 s40, 0
    s_cselect_b32 s64, s62, s63
    s_andn2_b32 s64, 0xffff, s64
    s_min_u32 s64, s64, 2047
    s_mul_i32 s65, s64, 1280
    buffer_load_dwordx3 v[52:54], v14, s[32:35], s65 offen
    buffer_load_dwordx3 v[56:58], v14, s[32:35], s65 offen offset:768
    s_and_b32 s60, s64, 7
    s_mul_i32 s61, s60, 43
    s_lshr_b32 s61, s61, 7
    s_mul_i32 s65, s61, 3
    s_sub_u32 s60, s60, s65
    s_lshl_b32 s61, s61, 4
    s_lshr_b32 s64, s64, 3
    s_lshl_b32 s64, s64, 6
    s_add_u32 s64, s64, s61
    s_add_u32 s64, s64, 7012368
    v_mov_b32 v3, s64
    v_mov_b32 v48, s62
    v_mov_b32 v49, s63
    s_lshl_b32 s62, s40, 11
    s_lshl_b32 s64, s41, 12
    s_add_u32 s63, s62, s64
    s_add_u32 s63, s63, 7029888
    s_mov_b32 s68, 200000
    s_mov_b64 s[66:67], exec
L_poll_35:
    buffer_load_dwordx4 v[32:35], v3, s[36:39], 0 offen sc1
    s_waitcnt vmcnt(0)
    v_cmpx_eq_u32 vcc, s45, v35
    s_andn2_b64 s[66:67], s[66:67], exec
    s_cbranch_scc0 L_pollx_36
    s_mov_b64 exec, s[66:67]
    s_sub_u32 s68, s68, 1
    s_sleep 1
    s_cmp_lg_u32 s68, 0
    s_cbranch_scc1 L_poll_35
L_pollx_36:
    s_mov_b64 exec, -1
    s_cmp_eq_u32 s60, 1
    s_cselect_b64 vcc, -1, 0
    v_cndmask_b32 v32, v32, v33, vcc
    s_cmp_eq_u32 s60, 2
    s_cselect_b64 vcc, -1, 0
    v_cndmask_b32 v32, v32, v34, vcc
    v_and_b32 v33, 0xffff0000, v32
    v_rcp_f32 v33, v33
    v_lshlrev_b32 v32, 16, v32
    v_lshlrev_b32 v36, 16, v52
    v_and_b32 v37, 0xffff0000, v52
    v_lshlrev_b32 v38, 16, v53
    v_and_b32 v39, 0xffff0000, v53
    v_lshlrev_b32 v40, 16, v54
    v_and_b32 v41, 0xffff0000, v54
    v_lshlrev_b32 v42, 16, v56
    v_and_b32 v43, 0xffff0000, v56
    v_lshlrev_b32 v44, 16, v57
    v_and_b32 v45, 0xffff0000, v57
    v_lshlrev_b32 v46, 16, v58
    v_and_b32 v47, 0xffff0000, v58
    v_pk_add_f32 v[36:37], v[36:37], v[32:33] op_sel_hi:[1,0] neg_lo:[0,1] neg_hi:[0,1]
    v_pk_add_f32 v[38:39], v[38:39], v[32:33] op_sel_hi:[1,0] neg_lo:[0,1] neg_hi:[0,1]
    v_pk_add_f32 v[40:41], v[40:41], v[32:33] op_sel_hi:[1,0] neg_lo:[0,1] neg_hi:[0,1]
    v_pk_add_f32 v[42:43], v[42:43], v[32:33] op_sel_hi:[1,0] neg_lo:[0,1] neg_hi:[0,1]
    v_pk_add_f32 v[44:45], v[44:45], v[32:33] op_sel_hi:[1,0] neg_lo:[0,1] neg_hi:[0,1]
    v_pk_add_f32 v[46:47], v[46:47], v[32:33] op_sel_hi:[1,0] neg_lo:[0,1] neg_hi:[0,1]
    v_cvt_pk_bf16_f32 v52, v36, v37
    v_cvt_pk_bf16_f32 v53, v38, v39
    v_cvt_pk_bf16_f32 v54, v40, v41
    v_cvt_pk_bf16_f32 v56, v42, v43
    v_cvt_pk_bf16_f32 v57, v44, v45
    v_cvt_pk_bf16_f32 v58, v46, v47
    v_lshlrev_b32 v36, 16, v52
    v_and_b32 v37, 0xffff0000, v52
    v_lshlrev_b32 v38, 16, v53
    v_and_b32 v39, 0xffff0000, v53
    v_lshlrev_b32 v40, 16, v54
    v_and_b32 v41, 0xffff0000, v54
    v_lshlrev_b32 v42, 16, v56
    v_and_b32 v43, 0xffff0000, v56
    v_lshlrev_b32 v44, 16, v57
    v_and_b32 v45, 0xffff0000, v57
    v_lshlrev_b32 v46, 16, v58
    v_and_b32 v47, 0xffff0000, v58
    v_pk_mul_f32 v[36:37], v[36:37], v[32:33] op_sel:[0,1] op_sel_hi:[1,1]
    v_pk_mul_f32 v[38:39], v[38:39], v[32:33] op_sel:[0,1] op_sel_hi:[1,1]
    v_pk_mul_f32 v[40:41], v[40:41], v[32:33] op_sel:[0,1] op_sel_hi:[1,1]
    v_pk_mul_f32 v[42:43], v[42:43], v[32:33] op_sel:[0,1] op_sel_hi:[1,1]
    v_pk_mul_f32 v[44:45], v[44:45], v[32:33] op_sel:[0,1] op_sel_hi:[1,1]
    v_pk_mul_f32 v[46:47], v[46:47], v[32:33] op_sel:[0,1] op_sel_hi:[1,1]
    v_cvt_pk_bf16_f32 v52, v36, v37
    v_cvt_pk_bf16_f32 v53, v38, v39
    v_cvt_pk_bf16_f32 v54, v40, v41
    buffer_store_dwordx4 v[52:55], v5, s[36:39], s63 offen sc1
    v_cvt_pk_bf16_f32 v56, v42, v43
    v_cvt_pk_bf16_f32 v57, v44, v45
    v_cvt_pk_bf16_f32 v58, v46, v47
    buffer_store_dwordx4 v[56:59], v5, s[36:39], s63 offen offset:1024 sc1
    v_dot2_f32_bf16 v13, v52, v60, 0
    v_dot2_f32_bf16 v13, v53, v61, v13
    v_dot2_f32_bf16 v13, v54, v62, v13
    s_mov_b32 exec_hi, 0x7ff
    v_dot2_f32_bf16 v13, v56, v64, v13
    v_dot2_f32_bf16 v13, v57, v65, v13
    s_mov_b32 exec_hi, 0x3ff
    v_dot2_f32_bf16 v13, v58, v66, v13
    s_mov_b64 exec, -1
    s_nop 1
    v_add_f32_dpp v13, v13, v13 row_shr:1 row_mask:0xf bank_mask:0xf bound_ctrl:0
    s_nop 1
    v_add_f32_dpp v13, v13, v13 row_shr:2 row_mask:0xf bank_mask:0xf bound_ctrl:0
    s_nop 1
    v_add_f32_dpp v13, v13, v13 row_shr:4 row_mask:0xf bank_mask:0xf bound_ctrl:0
    s_nop 1
    v_add_f32_dpp v13, v13, v13 row_shr:8 row_mask:0xf bank_mask:0xf bound_ctrl:0
    s_nop 1
    v_add_f32_dpp v13, v13, v13 row_bcast:15 row_mask:0xa bank_mask:0xf
    s_nop 1
    v_add_f32_dpp v13, v13, v13 row_bcast:31 row_mask:0xc bank_mask:0xf
    s_nop 1
    v_cvt_pk_bf16_f32 v13, v13, v13
    v_lshlrev_b32 v13, 16, v13
    s_lshl_b32 s64, s41, 7
    v_readlane_b32 s62, v13, 63
    s_lshl_b32 s63, s40, 6
    s_add_u32 s64, s64, s63
    s_add_u32 s63, s64, 7028736
    v_mov_b32 v50, s62
    s_mov_b64 exec, 0xf
    buffer_store_dwordx4 v[48:51], v5, s[36:39], s63 offen sc1
    s_cmp_lg_u32 s64, 0
    s_cbranch_scc1 L_done
    s_mov_b32 s63, 7029760
    s_mov_b64 exec, 1
    buffer_store_dword v51, v5, s[36:39], s63 offen
    s_branch L_done
L_slow:
    v_readlane_b32 s64, v62, 0
    v_lshlrev_b32 v68, 16, v8
    v_and_b32 v69, 0xffff0000, v8
    v_lshlrev_b32 v70, 16, v9
    v_and_b32 v71, 0xffff0000, v9
    v_lshlrev_b32 v72, 16, v10
    v_and_b32 v73, 0xffff0000, v10
    v_lshlrev_b32 v74, 16, v11
    v_and_b32 v75, 0xffff0000, v11
    v_lshlrev_b32 v76, 16, v12
    v_and_b32 v77, 0xffff0000, v12
    v_subrev_f32 v68, s64, v68
    v_subrev_f32 v69, s64, v69
    v_subrev_f32 v70, s64, v70
    v_subrev_f32 v71, s64, v71
    v_subrev_f32 v72, s64, v72
    v_subrev_f32 v73, s64, v73
    v_subrev_f32 v74, s64, v74
    v_subrev_f32 v75, s64, v75
    v_subrev_f32 v76, s64, v76
    v_subrev_f32 v77, s64, v77
    v_mul_f32 v49, v68, v68
    v_fmac_f32 v49, v69, v69
    v_fmac_f32 v49, v70, v70
    v_fmac_f32 v49, v71, v71
    v_fmac_f32 v49, v72, v72
    v_fmac_f32 v49, v73, v73
    v_fmac_f32 v49, v74, v74
    v_fmac_f32 v49, v75, v75
    v_fmac_f32 v49, v76, v76
    v_fmac_f32 v49, v77, v77
    v_readlane_b32 s64, v62, 16
    v_lshlrev_b32 v68, 16, v16
    v_and_b32 v69, 0xffff0000, v16
    v_lshlrev_b32 v70, 16, v17
    v_and_b32 v71, 0xffff0000, v17
    v_lshlrev_b32 v72, 16, v18
    v_and_b32 v73, 0xffff0000, v18
    v_lshlrev_b32 v74, 16, v19
    v_and_b32 v75, 0xffff0000, v19
    v_lshlrev_b32 v76, 16, v20
    v_and_b32 v77, 0xffff0000, v20
    v_subrev_f32 v68, s64, v68
    v_subrev_f32 v69, s64, v69
    v_subrev_f32 v70, s64, v70
    v_subrev_f32 v71, s64, v71
    v_subrev_f32 v72, s64, v72
    v_subrev_f32 v73, s64, v73
    v_subrev_f32 v74, s64, v74
    v_subrev_f32 v75, s64, v75
    v_subrev_f32 v76, s64, v76
    v_subrev_f32 v77, s64, v77
    v_mul_f32 v50, v68, v68
    v_fmac_f32 v50, v69, v69
    v_fmac_f32 v50, v70, v70
    v_fmac_f32 v50, v71, v71
    v_fmac_f32 v50, v72, v72
    v_fmac_f32 v50, v73, v73
    v_fmac_f32 v50, v74, v74
    v_fmac_f32 v50, v75, v75
    v_fmac_f32 v50, v76, v76
    v_fmac_f32 v50, v77, v77
    v_readlane_b32 s64, v62, 32
    v_lshlrev_b32 v68, 16, v24
    v_and_b32 v69, 0xffff0000, v24
    v_lshlrev_b32 v70, 16, v25
    v_and_b32 v71, 0xffff0000, v25
    v_lshlrev_b32 v72, 16, v26
    v_and_b32 v73, 0xffff0000, v26
    v_lshlrev_b32 v74, 16, v27
    v_and_b32 v75, 0xffff0000, v27
    v_lshlrev_b32 v76, 16, v28
    v_and_b32 v77, 0xffff0000, v28
    v_subrev_f32 v68, s64, v68
    v_subrev_f32 v69, s64, v69
    v_subrev_f32 v70, s64, v70
    v_subrev_f32 v71, s64, v71
    v_subrev_f32 v72, s64, v72
    v_subrev_f32 v73, s64, v73
    v_subrev_f32 v74, s64, v74
    v_subrev_f32 v75, s64, v75
    v_subrev_f32 v76, s64, v76
    v_subrev_f32 v77, s64, v77
    v_mul_f32 v51, v68, v68
    v_fmac_f32 v51, v69, v69
    v_fmac_f32 v51, v70, v70
    v_fmac_f32 v51, v71, v71
    v_fmac_f32 v51, v72, v72
    v_fmac_f32 v51, v73, v73
    v_fmac_f32 v51, v74, v74
    v_fmac_f32 v51, v75, v75
    v_fmac_f32 v51, v76, v76
    v_fmac_f32 v51, v77, v77
    v_readlane_b32 s64, v62, 48
    v_lshlrev_b32 v68, 16, v32
    v_and_b32 v69, 0xffff0000, v32
    v_lshlrev_b32 v70, 16, v33
    v_and_b32 v71, 0xffff0000, v33
    v_lshlrev_b32 v72, 16, v34
    v_and_b32 v73, 0xffff0000, v34
    v_lshlrev_b32 v74, 16, v35
    v_and_b32 v75, 0xffff0000, v35
    v_lshlrev_b32 v76, 16, v36
    v_and_b32 v77, 0xffff0000, v36
    v_subrev_f32 v68, s64, v68
    v_subrev_f32 v69, s64, v69
    v_subrev_f32 v70, s64, v70
    v_subrev_f32 v71, s64, v71
    v_subrev_f32 v72, s64, v72
    v_subrev_f32 v73, s64, v73
    v_subrev_f32 v74, s64, v74
    v_subrev_f32 v75, s64, v75
    v_subrev_f32 v76, s64, v76
    v_subrev_f32 v77, s64, v77
    v_mul_f32 v52, v68, v68
    v_fmac_f32 v52, v69, v69
    v_fmac_f32 v52, v70, v70
    v_fmac_f32 v52, v71, v71
    v_fmac_f32 v52, v72, v72
    v_fmac_f32 v52, v73, v73
    v_fmac_f32 v52, v74, v74
    v_fmac_f32 v52, v75, v75
    v_fmac_f32 v52, v76, v76
    v_fmac_f32 v52, v77, v77
    s_nop 1
    v_permlane32_swap_b32 v49, v51
    v_permlane32_swap_b32 v50, v52
    s_nop 0
    v_add_f32 v49, v49, v51
    v_add_f32 v50, v50, v52
    s_nop 1
    v_permlane16_swap_b32 v49, v50
    s_nop 0
    v_add_f32 v49, v49, v50
    s_nop 1
    v_add_f32_dpp v49, v49, v49 row_ror:8 row_mask:0xf bank_mask:0xf
    s_nop 1
    v_add_f32_dpp v49, v49, v49 row_ror:4 row_mask:0xf bank_mask:0xf
    s_nop 1
    v_add_f32_dpp v49, v49, v49 row_ror:2 row_mask:0xf bank_mask:0xf
    s_nop 1
    v_add_f32_dpp v49, v49, v49 row_ror:1 row_mask:0xf bank_mask:0xf
    v_mul_f32 v63, v49, v2
    s_branch L_vok
L_done:
L_end:
    s_endpgm
.section .rodata,"a"
.p2align 6
.amdhsa_kernel parallel_sum__ssm_conv_h3__moe_arch_mod__prompt_kernel
  .amdhsa_next_free_vgpr 248
  .amdhsa_next_free_sgpr 72
  .amdhsa_accum_offset 248
  .amdhsa_group_segment_fixed_size 0
  .amdhsa_kernarg_size 112
  .amdhsa_user_sgpr_count 2
  .amdhsa_user_sgpr_kernarg_segment_ptr 1
  .amdhsa_system_sgpr_workgroup_id_x 1
  .amdhsa_float_denorm_mode_32 3
.end_amdhsa_kernel
```
